```python
import torch

def _softmax(x, axis=-1):
    return torch.softmax(x, dim=axis)

def _gelu(x):
    return torch.nn.functional.gelu(x, approximate='tanh')

def _silu(x):
    return torch.nn.functional.silu(x)

def _sigmoid(x):
    return torch.sigmoid(x)

def _layernorm(x, axis=-1, eps=1e-05):
    m = x.mean(dim=axis, keepdim=True)
    v = x.var(dim=axis, keepdim=True, unbiased=False)
    return (x - m) / torch.sqrt(v + eps)

def _scatter_add(tgt, idx, src, axis=0):
    return tgt.clone().index_add_(axis, idx, src)

def _segment_sum(src, seg, n):
    out = torch.zeros((n,) + src.shape[1:], dtype=src.dtype)
    return out.index_add_(0, seg, src)

def _pad(x, pw):
    flat = tuple((v for pair in reversed(pw) for v in pair))
    return torch.nn.functional.pad(x, flat)
kernel_name = 'adaLN_cond__ssm_conv_h3__moe_arch_mod__prompt'

def setup_inputs():

    _w = lambda a: (lambda t: t.to(torch.bfloat16) if t.is_floating_point() else t)(torch.as_tensor(a))

    def _A_setup():
        B, S, D = (1, 2048, 640)
        ks = 4
        return {'q': _w((lambda *s: torch.randn(*s, dtype=torch.bfloat16) * 0.05)(B, S, D)), 'k': _w((lambda *s: torch.randn(*s, dtype=torch.bfloat16) * 0.4)(B, S, D)), 'v': _w((lambda *s: torch.randn(*s, dtype=torch.bfloat16) * 0.4)(B, S, D)), 'shift_k': _w((lambda *s: torch.randn(*s, dtype=torch.bfloat16) * 0.4)(D, ks) * 0.5), 'ssm_k': _w((lambda *s: torch.randn(*s, dtype=torch.bfloat16) * 0.8)(D, S) * (1.0 / S ** 0.5)), 'ssm_D': _w((lambda *s: torch.randn(*s, dtype=torch.bfloat16) * 0.4)(D))}
    _A_in = _A_setup()

    def _B_setup():
        B, S, D, F, C = (1, 2048, 640, 1728, 2)
        return {'x': _w((lambda *s: torch.randn(*s, dtype=torch.bfloat16) * 0.05)(B, S, D)), 'w_r': _w((lambda *s: torch.randn(*s, dtype=torch.bfloat16) * 0.05)(D)), 'w_gate': _w((lambda *s: torch.randn(*s, dtype=torch.bfloat16) * 0.05)(D, F)), 'w_up': _w((lambda *s: torch.randn(*s, dtype=torch.bfloat16) * 0.05)(D, F)), 'w_down': _w((lambda *s: torch.randn(*s, dtype=torch.bfloat16) * 0.05)(F, D))}
    _B_in = _B_setup()
    return {'A_q': _A_in['q'], 'A_k': _A_in['k'], 'A_v': _A_in['v'], 'A_shift_k': _A_in['shift_k'], 'A_ssm_k': _A_in['ssm_k'], 'A_ssm_D': _A_in['ssm_D'], 'B_x': _B_in['x'], 'B_w_r': _B_in['w_r'], 'B_w_gate': _B_in['w_gate'], 'B_w_up': _B_in['w_up'], 'B_w_down': _B_in['w_down'], 'c': _w((lambda *s: torch.randn(*s, dtype=torch.bfloat16) * 0.2)(1, 640) * 8.0), 'w_mod': _w((lambda *s: torch.randn(*s, dtype=torch.bfloat16) * 0.2)(640, 6 * 640) * 640 ** (-0.5) * 8.0)}

def reference(A_q, A_k, A_v, A_shift_k, A_ssm_k, A_ssm_D, B_x, B_w_r, B_w_gate, B_w_up, B_w_down, c, w_mod):

    def _A_ref(q, k, v, shift_k, ssm_k, ssm_D):
        B, S, D = q.shape
        ks = shift_k.shape[-1]
        k_pad = _pad(k, ((0, 0), (ks - 1, 0), (0, 0)))
        k_shift = torch.zeros_like(k)
        for t in range(ks):
            k_shift = k_shift + k_pad[:, t:t + S, :] * shift_k[:, ks - 1 - t][None, None, :]
        kv = k_shift * v
        L = 2 * S
        kv_pad = _pad(kv, ((0, 0), (0, S), (0, 0)))
        kf_pad = _pad(ssm_k, ((0, 0), (0, S)))
        kv_f = (lambda x, axes=(-2, -1): torch.fft.rfft2(x.float(), dim=axes))(kv_pad[:, None, :, :], axes=(1, 2))
        kf_f = (lambda x, axes=(-2, -1): torch.fft.rfft2(x.float(), dim=axes))(kf_pad[:, None, :], axes=(1, 2))
        kf_f = (lambda x, *d: x.permute(*d))(kf_f, 1, 2, 0)
        y_f = kv_f * kf_f[None, :, :, :]
        y = (lambda x, s, axes=(-2, -1): torch.fft.irfft2(x, s=s, dim=axes).to(torch.bfloat16))(y_f, (1, L), axes=(1, 2))[:, 0, :S, :]
        y = y + kv * ssm_D[None, None, :]
        return q * y

    def _B_ref(x, w_r, w_gate, w_up, w_down):
        B, S, D = x.shape
        C = 2
        r = x @ w_r
        idx = torch.argsort(-r, axis=-1)[:, :C]
        idx_e = (lambda x, n, axis: torch.repeat_interleave(x, n, dim=axis))(idx.reshape(B, C, 1), D, axis=2)
        x_sel = (lambda x, i, axis: torch.take_along_dim(x, i, dim=axis))(x, idx_e, axis=1)
        g = _silu(x_sel @ w_gate)
        u = x_sel @ w_up
        y = g * u @ w_down
        r_sel = _sigmoid((lambda x, i, axis: torch.take_along_dim(x, i, dim=axis))(r, idx, axis=1))
        y = y * r_sel.reshape(B, C, 1)
        b_off = (torch.arange(B) * S).reshape(B, 1)
        flat_idx = (idx + b_off).reshape(B * C)
        zero = (x * 0.0).reshape(B * S, D)
        upd = _scatter_add(zero, flat_idx, y.reshape(B * C, D), axis=0)
        return x + upd.reshape(B, S, D)
    x = A_q
    mod = (_silu(c) @ w_mod).reshape(c.shape[0], 6, 1, -1)
    sa, ca, ga, sb, cb, gb = (mod[:, 0].clone(), mod[:, 1].clone(), mod[:, 2].clone(), mod[:, 3].clone(), mod[:, 4].clone(), mod[:, 5].clone())
    h = _layernorm(x, axis=-1) * (1 + ca) + sa
    x = x + ga * _A_ref(h, A_k, A_v, A_shift_k, A_ssm_k, A_ssm_D)
    h = _layernorm(x, axis=-1) * (1 + cb) + sb
    x = x + gb * _B_ref(h, B_w_r, B_w_gate, B_w_up, B_w_down)
    return x
```

```asm
; @launch grid=(256,1,1) block=(512,1,1) lds=153344
.amdgcn_target "amdgcn-amd-amdhsa--gfx950"
.text
.globl adaLN_cond__ssm_conv_h3__moe_arch_mod__prompt_kernel
.p2align 8
.type adaLN_cond__ssm_conv_h3__moe_arch_mod__prompt_kernel,@function
adaLN_cond__ssm_conv_h3__moe_arch_mod__prompt_kernel:
    s_cmp_ge_u32 s2, 256
    s_cbranch_scc1 L_END
    s_load_dwordx16 s[16:31], s[0:1], 0
    s_load_dwordx16 s[32:47], s[0:1], 64
    v_lshrrev_b32 v3, 6, v0
    v_and_b32 v1, 63, v0
    v_readfirstlane_b32 s3, v3
    s_and_b32 s4, s2, 7
    s_lshr_b32 s5, s2, 3
    v_mul_u32_u24 v3, 6554, v0
    v_lshrrev_b32 v3, 16, v3
    v_mul_u32_u24 v3, 1120, v3
    v_lshl_add_u32 v4, v0, 4, v3
    s_mul_i32 s6, s5, 81920
    s_mul_i32 s7, s4, 160
    s_add_u32 s52, s6, s7
    s_sub_u32 s9, s52, 5120
    v_add_u32 v5, s52, v4
    v_add_u32 v4, s9, v4
    s_lshl_b32 s74, s3, 10
    s_add_u32 s75, s74, 89600
    s_add_u32 s74, s74, 78336
    s_mov_b32 m0, s74
    s_mov_b32 s50, 2621440
    s_mov_b32 s51, 0x20000
    v_and_b32 v3, 255, v0
    v_add_u32 v3, 512, v3
    v_mul_u32_u24 v6, 6554, v3
    v_lshrrev_b32 v6, 16, v6
    v_mul_u32_u24 v6, 1120, v6
    v_lshl_add_u32 v10, v3, 4, v6
    s_and_b32 s15, s3, 3
    s_cmp_ge_u32 s3, 4
    s_cselect_b32 s76, s52, s9
    v_add_u32 v35, s76, v10
    s_mul_i32 s6, s4, 640
    v_and_b32 v3, 15, v1
    v_lshlrev_b32 v34, 3, v3
    v_add_u32 v34, s6, v34
    s_min_u32 s8, s2, 239
    s_mul_i32 s81, s8, 1093
    s_lshr_b32 s81, s81, 16
    s_mul_i32 s76, s81, 60
    s_sub_u32 s8, s8, s76
    s_mul_i32 s76, s81, 320
    s_mul_i32 s77, s15, 80
    s_add_u32 s76, s76, s77
    v_min_u32 v36, 39, v1
    v_lshlrev_b32 v36, 1, v36
    v_add_u32 v37, s76, v36
    v_lshlrev_b32 v2, 4, v1
    s_cmp_ge_u32 s5, 20
    s_cselect_b32 s53, 1, 0
    s_min_u32 s76, s5, 29
    s_sub_u32 s77, s76, 10
    s_lshl_b32 s77, s77, 1
    s_sub_u32 s77, s77, 20
    s_cmp_eq_u32 s53, 1
    s_cselect_b32 s76, s77, s76
    s_lshl_b32 s76, s76, 2
    s_lshl_b32 s77, s15, s53
    s_add_u32 s76, s76, s77
    s_mul_i32 s6, s4, 80
    s_add_u32 s54, s76, s6
    s_lshl_b32 s76, 2048, s53
    v_add_u32 v68, s76, v2
    s_cmp_lt_u32 s3, 4
    s_waitcnt lgkmcnt(0)
    s_cbranch_scc1 L_NOC
    global_load_ushort v116, v37, s[38:39]
    s_lshl_b32 s76, s54, 12
    s_add_u32 s24, s24, s76
    s_addc_u32 s25, s25, 0
    global_load_dwordx4 v[12:15], v2, s[24:25]
    global_load_dwordx4 v[16:19], v2, s[24:25] offset:1024
    global_load_dwordx4 v[20:23], v68, s[24:25]
    global_load_dwordx4 v[24:27], v68, s[24:25] offset:1024
L_NOC:
    s_mov_b32 s48, s18
    s_mov_b32 s49, s19
    s_load_dwordx2 s[10:11], s[46:47], 0
    buffer_load_dwordx4 v4, s[48:51], 0 offen lds
    s_mov_b32 m0, s75
    s_cmp_ge_u32 s3, 4
    global_load_lds_dwordx4 v5, s[20:21]
    s_cbranch_scc1 L_HELPER
    s_cmp_ge_u32 s3, 3
    s_cbranch_scc1 L_1
    s_add_u32 s74, s74, 8192
    s_mov_b32 m0, s74
    s_nop 0
    buffer_load_dwordx4 v35, s[48:51], 0 offen lds
L_1:
    s_sub_u32 s78, s3, 1
    s_cselect_b32 s78, 4, s78
    s_add_u32 s79, s3, 3
    s_min_u32 s79, s79, 4
    s_lshl_b32 s76, s3, 7
    v_add_u32 v4, s76, v34
    global_load_dwordx2 v[16:17], v4, s[22:23]
    s_lshl_b32 s76, s78, 7
    v_add_u32 v4, s76, v34
    global_load_dwordx2 v[18:19], v4, s[22:23]
    s_lshl_b32 s76, s79, 7
    v_add_u32 v4, s76, v34
    global_load_dwordx2 v[20:21], v4, s[22:23]
    s_barrier
    s_setprio 3
    v_lshrrev_b32 v7, 4, v1
    v_bfe_u32 v33, v1, 2, 2
    v_lshl_add_u32 v33, v7, 3, v33
    v_mul_u32_u24 v33, 160, v33
    v_and_b32 v34, 3, v1
    v_lshl_add_u32 v56, v34, 3, v33
    v_lshlrev_b32 v33, 12, v3
    v_lshl_add_u32 v33, v7, 4, v33
    s_lshl_b32 s77, s3, 16
    v_add_u32 v24, s77, v33
    s_lshl_b32 s77, s3, 5
    s_add_u32 s77, s77, 78336
    v_add_u32 v27, s77, v56
    s_cmp_eq_u32 s3, 0
    s_cselect_b32 s6, 0, 64
    s_mov_b32 s7, 83456
    s_cmov_b32 s7, 78336
    s_lshl_b32 s77, s78, 16
    s_add_u32 s77, s77, s6
    v_add_u32 v25, s77, v33
    s_lshl_b32 s77, s78, 5
    s_add_u32 s77, s77, s7
    v_add_u32 v28, s77, v56
    s_lshl_b32 s77, s79, 16
    s_add_u32 s77, s77, 64
    v_add_u32 v26, s77, v33
    s_lshl_b32 s77, s79, 5
    s_add_u32 s77, s77, 83456
    v_add_u32 v29, s77, v56
    v_and_b32 v4, 255, v0
    v_mul_u32_u24 v6, 6554, v4
    v_lshrrev_b32 v6, 16, v6
    v_mul_u32_u24 v6, 1120, v6
    v_lshl_add_u32 v8, v4, 4, v6
    v_add_u32 v4, 256, v4
    v_mul_u32_u24 v6, 6554, v4
    v_lshrrev_b32 v6, 16, v6
    v_mul_u32_u24 v6, 1120, v6
    v_lshl_add_u32 v9, v4, 4, v6
    s_getreg_b32 s13, hwreg(HW_REG_XCC_ID)
    s_cmp_eq_u32 s53, 1
    s_mov_b32 s56, 4768
    s_cmov_b32 s56, 2720
    s_mov_b32 s57, 9536
    s_cmov_b32 s57, 5440
    s_mov_b32 s58, 4224
    s_cmov_b32 s58, 2176
    s_mov_b32 s59, 17984
    s_cmov_b32 s59, 9792
    s_lshl_b32 s77, s15, s53
    s_mul_i32 s55, s77, s59
    s_and_b32 s13, s13, 15
    s_lshl_b32 s74, s4, 5
    s_add_u32 s74, s74, s5
    s_lshl_b32 s74, s74, 10
    s_add_u32 s74, s74, 32768
    s_add_u32 s66, s46, s74
    s_addc_u32 s67, s47, 0
    s_mul_i32 s74, s5, 24576
    s_add_u32 s74, s74, 458752
    s_add_u32 s68, s46, s74
    s_addc_u32 s69, s47, 0
    s_lshl_b32 s74, s4, 12
    s_add_u32 s74, s74, 425984
    s_add_u32 s70, s46, s74
    s_addc_u32 s71, s47, 0
    s_lshl_b32 s7, s15, 10
    s_add_u32 s74, s15, 8
    s_cmp_lt_u32 s15, 2
    s_cselect_b32 s0, s74, s15
    s_cselect_b64 vcc, -1, 0
    s_lshl_b32 s8, s0, 10
    v_cndmask_b32 v10, v8, v10, vcc
    s_mul_i32 s74, s4, 327680
    s_lshl_b32 s75, s5, 7
    s_add_u32 s74, s74, s75
    s_add_u32 s75, s74, 2097152
    s_add_u32 s22, s46, s75
    s_addc_u32 s23, s47, 0
    s_cmp_ge_u32 s5, 16
    s_mov_b32 s76, 5242880
    s_cmov_b32 s76, 2097152
    s_add_u32 s74, s74, s76
    s_add_u32 s18, s46, s74
    s_addc_u32 s19, s47, 0
    s_lshl_b32 s74, s4, 11
    s_add_u32 s74, s74, 4096
    s_add_u32 s62, s46, s74
    s_addc_u32 s63, s47, 0
    s_lshl_b32 s75, s5, 5
    s_lshl_b32 s76, s3, 3
    s_add_u32 s75, s75, s76
    v_mov_b32 v59, s75
    s_mov_b32 s80, 0xffff
    v_mov_b32 v144, 151892
    s_waitcnt lgkmcnt(0)
    s_mul_i32 s10, s10, 0x9E3779B1
    s_add_u32 s10, s10, 0x7F4A7C15
    s_or_b32 s10, s10, 1
    s_mul_i32 s11, s11, 0x85EBCA6B
    s_add_u32 s11, s11, 0xC2B2AE35
    v_mov_b32 v32, s10
    v_mov_b32 v33, s11
    s_cmp_eq_u32 s3, 1
    s_cbranch_scc1 L_5
    s_cmp_eq_u32 s3, 2
    s_cbranch_scc1 L_2
    s_cmp_eq_u32 s3, 3
    s_cbranch_scc1 L_3
    s_waitcnt vmcnt(0)
L_4:
    s_barrier
L_P0:
    ds_read_b64_tr_b16 v[86:87], v27 offset:640
    ds_read_b64_tr_b16 v[88:89], v27 offset:1280
    ds_read_b64_tr_b16 v[84:85], v27
    ds_read_b64_tr_b16 v[90:91], v27 offset:11264
    ds_read_b64_tr_b16 v[92:93], v27 offset:11904
    ds_read_b64_tr_b16 v[96:97], v28 offset:640
    ds_read_b64_tr_b16 v[98:99], v28 offset:1280
    ds_read_b64_tr_b16 v[94:95], v28
    ds_read_b64_tr_b16 v[100:101], v28 offset:11264
    ds_read_b64_tr_b16 v[102:103], v28 offset:11904
    s_cmp_ge_u32 s3, 2
    s_cbranch_scc1 L_6
    ds_read_b64_tr_b16 v[106:107], v29 offset:640
    ds_read_b64_tr_b16 v[108:109], v29 offset:1280
    ds_read_b64_tr_b16 v[104:105], v29
    ds_read_b64_tr_b16 v[110:111], v29 offset:11264
    ds_read_b64_tr_b16 v[112:113], v29 offset:11904
L_6:
    v_alignbit_b32 v64, v16, v16, 16
    v_alignbit_b32 v65, v17, v17, 16
    v_and_b32 v66, 0xffff, v16
    v_bfi_b32 v67, s80, v17, v16
    v_and_b32 v68, 0xffff0000, v17
    v_alignbit_b32 v69, v18, v18, 16
    v_alignbit_b32 v70, v19, v19, 16
    v_and_b32 v71, 0xffff, v18
    v_bfi_b32 v72, s80, v19, v18
    v_and_b32 v73, 0xffff0000, v19
    v_alignbit_b32 v74, v20, v20, 16
    v_alignbit_b32 v75, v21, v21, 16
    v_and_b32 v76, 0xffff, v20
    v_bfi_b32 v77, s80, v21, v20
    v_and_b32 v78, 0xffff0000, v21
    s_waitcnt lgkmcnt(5)
    v_dot2_f32_bf16 v114, v86, v66, 0
    v_dot2_f32_bf16 v115, v86, v64, 0
    v_dot2_f32_bf16 v116, v87, v66, 0
    v_dot2_f32_bf16 v117, v87, v64, 0
    v_dot2_f32_bf16 v118, v88, v66, 0
    v_dot2_f32_bf16 v119, v88, v64, 0
    v_dot2_f32_bf16 v120, v89, v66, 0
    v_dot2_f32_bf16 v121, v89, v64, 0
    v_dot2_f32_bf16 v114, v85, v67, v114
    v_dot2_f32_bf16 v115, v85, v65, v115
    v_dot2_f32_bf16 v116, v86, v67, v116
    v_dot2_f32_bf16 v117, v86, v65, v117
    v_dot2_f32_bf16 v118, v87, v67, v118
    v_dot2_f32_bf16 v119, v87, v65, v119
    v_dot2_f32_bf16 v120, v88, v67, v120
    v_dot2_f32_bf16 v121, v88, v65, v121
    v_dot2_f32_bf16 v114, v84, v68, v114
    v_dot2_f32_bf16 v116, v85, v68, v116
    v_dot2_f32_bf16 v118, v86, v68, v118
    v_dot2_f32_bf16 v120, v87, v68, v120
    v_lshlrev_b32 v122, 16, v90
    v_and_b32 v123, 0xffff0000, v90
    v_lshlrev_b32 v124, 16, v91
    v_and_b32 v125, 0xffff0000, v91
    v_lshlrev_b32 v126, 16, v92
    v_and_b32 v127, 0xffff0000, v92
    v_lshlrev_b32 v128, 16, v93
    v_and_b32 v129, 0xffff0000, v93
    v_pk_mul_f32 v[114:115], v[114:115], v[122:123]
    v_pk_mul_f32 v[116:117], v[116:117], v[124:125]
    v_pk_mul_f32 v[118:119], v[118:119], v[126:127]
    v_pk_mul_f32 v[120:121], v[120:121], v[128:129]
    v_cvt_pk_bf16_f32 v130, v114, v115
    v_cvt_pk_bf16_f32 v131, v116, v117
    v_cvt_pk_bf16_f32 v132, v118, v119
    v_cvt_pk_bf16_f32 v133, v120, v121
    global_store_dwordx4 v24, v[130:133], s[22:23]
    s_waitcnt lgkmcnt(0)
    v_dot2_f32_bf16 v114, v96, v71, 0
    v_dot2_f32_bf16 v115, v96, v69, 0
    v_dot2_f32_bf16 v116, v97, v71, 0
    v_dot2_f32_bf16 v117, v97, v69, 0
    v_dot2_f32_bf16 v118, v98, v71, 0
    v_dot2_f32_bf16 v119, v98, v69, 0
    v_dot2_f32_bf16 v120, v99, v71, 0
    v_dot2_f32_bf16 v121, v99, v69, 0
    v_dot2_f32_bf16 v114, v95, v72, v114
    v_dot2_f32_bf16 v115, v95, v70, v115
    v_dot2_f32_bf16 v116, v96, v72, v116
    v_dot2_f32_bf16 v117, v96, v70, v117
    v_dot2_f32_bf16 v118, v97, v72, v118
    v_dot2_f32_bf16 v119, v97, v70, v119
    v_dot2_f32_bf16 v120, v98, v72, v120
    v_dot2_f32_bf16 v121, v98, v70, v121
    v_dot2_f32_bf16 v114, v94, v73, v114
    v_dot2_f32_bf16 v116, v95, v73, v116
    v_dot2_f32_bf16 v118, v96, v73, v118
    v_dot2_f32_bf16 v120, v97, v73, v120
    v_lshlrev_b32 v122, 16, v100
    v_and_b32 v123, 0xffff0000, v100
    v_lshlrev_b32 v124, 16, v101
    v_and_b32 v125, 0xffff0000, v101
    v_lshlrev_b32 v126, 16, v102
    v_and_b32 v127, 0xffff0000, v102
    v_lshlrev_b32 v128, 16, v103
    v_and_b32 v129, 0xffff0000, v103
    v_pk_mul_f32 v[114:115], v[114:115], v[122:123]
    v_pk_mul_f32 v[116:117], v[116:117], v[124:125]
    v_pk_mul_f32 v[118:119], v[118:119], v[126:127]
    v_pk_mul_f32 v[120:121], v[120:121], v[128:129]
    v_cvt_pk_bf16_f32 v134, v114, v115
    v_cvt_pk_bf16_f32 v135, v116, v117
    v_cvt_pk_bf16_f32 v136, v118, v119
    v_cvt_pk_bf16_f32 v137, v120, v121
    global_store_dwordx4 v25, v[134:137], s[22:23]
    s_cmp_ge_u32 s3, 2
    s_cbranch_scc1 L_7
    v_dot2_f32_bf16 v114, v106, v76, 0
    v_dot2_f32_bf16 v115, v106, v74, 0
    v_dot2_f32_bf16 v116, v107, v76, 0
    v_dot2_f32_bf16 v117, v107, v74, 0
    v_dot2_f32_bf16 v118, v108, v76, 0
    v_dot2_f32_bf16 v119, v108, v74, 0
    v_dot2_f32_bf16 v120, v109, v76, 0
    v_dot2_f32_bf16 v121, v109, v74, 0
    v_dot2_f32_bf16 v114, v105, v77, v114
    v_dot2_f32_bf16 v115, v105, v75, v115
    v_dot2_f32_bf16 v116, v106, v77, v116
    v_dot2_f32_bf16 v117, v106, v75, v117
    v_dot2_f32_bf16 v118, v107, v77, v118
    v_dot2_f32_bf16 v119, v107, v75, v119
    v_dot2_f32_bf16 v120, v108, v77, v120
    v_dot2_f32_bf16 v121, v108, v75, v121
    v_dot2_f32_bf16 v114, v104, v78, v114
    v_dot2_f32_bf16 v116, v105, v78, v116
    v_dot2_f32_bf16 v118, v106, v78, v118
    v_dot2_f32_bf16 v120, v107, v78, v120
    v_lshlrev_b32 v122, 16, v110
    v_and_b32 v123, 0xffff0000, v110
    v_lshlrev_b32 v124, 16, v111
    v_and_b32 v125, 0xffff0000, v111
    v_lshlrev_b32 v126, 16, v112
    v_and_b32 v127, 0xffff0000, v112
    v_lshlrev_b32 v128, 16, v113
    v_and_b32 v129, 0xffff0000, v113
    v_pk_mul_f32 v[114:115], v[114:115], v[122:123]
    v_pk_mul_f32 v[116:117], v[116:117], v[124:125]
    v_pk_mul_f32 v[118:119], v[118:119], v[126:127]
    v_pk_mul_f32 v[120:121], v[120:121], v[128:129]
    v_cvt_pk_bf16_f32 v138, v114, v115
    v_cvt_pk_bf16_f32 v139, v116, v117
    v_cvt_pk_bf16_f32 v140, v118, v119
    v_cvt_pk_bf16_f32 v141, v120, v121
    global_store_dwordx4 v26, v[138:141], s[22:23]
L_7:
    v_mov_b32 v12, 0
    v_mov_b32 v13, 0
    v_mov_b32 v14, 0
    v_mov_b32 v15, 0
    v_lshrrev_b32 v4, 4, v1
    s_mul_i32 s74, s4, 3072
    s_add_u32 s60, s68, s74
    s_addc_u32 s61, s69, 0
    v_lshrrev_b32 v6, 1, v3
    v_sub_u32 v6, 7, v6
    v_lshlrev_b32 v6, 6, v6
    v_lshl_add_u32 v6, v4, 4, v6
    v_and_b32 v7, 1, v3
    v_mul_lo_u32 v34, v7, s56
    v_add3_u32 v34, v6, v34, s55
    v_xor_b32 v7, 1, v7
    s_add_u32 s74, s58, 4
    v_mul_lo_u32 v7, v7, s74
    v_lshlrev_b32 v6, 2, v3
    v_lshl_add_u32 v36, v4, 7, v6
    v_lshl_add_u32 v6, v4, 4, v6
    s_add_u32 s75, s55, s57
    s_add_u32 s74, s75, 4
    v_add3_u32 v35, v6, v7, s74
    s_add_u32 s48, s75, 64
    s_add_u32 s49, s48, s58
    s_cmp_eq_u32 s53, 1
    s_mov_b32 s76, 2048
    s_cmov_b32 s76, 4096
    s_mov_b32 s77, 2048
    s_cmov_b32 s77, 9792
    s_add_u32 s50, s48, s77
    s_add_u32 s51, s49, s77
    v_mov_b32 v37, s49
    v_add_u32 v40, s76, v2
    s_lshl_b32 s74, s54, 12
    s_add_u32 s76, s74, 2097152
    s_add_u32 s30, s46, s76
    s_addc_u32 s31, s47, 0
    s_sub_u32 s38, s30, 4
    s_subb_u32 s39, s31, 0
    s_cmp_eq_u32 s53, 1
    s_mov_b32 s77, 2099200
    s_cmov_b32 s77, 5242880
    s_add_u32 s76, s74, s77
    s_add_u32 s40, s46, s76
    s_addc_u32 s41, s47, 0
    s_mul_i32 s74, s4, 32768
    s_add_u32 s74, s74, 32768
    s_add_u32 s20, s46, s74
    s_addc_u32 s21, s47, 0
    v_lshrrev_b32 v6, 3, v1
    v_and_b32 v7, 7, v1
    v_lshlrev_b32 v7, 4, v7
    v_lshl_add_u32 v43, v6, 12, v7
    s_lshl_b32 s74, s3, 15
    v_add_u32 v41, s74, v43
    v_add_u32 v42, 131072, v41
    s_lshl_b32 s74, s0, 15
    v_add_u32 v43, s74, v43
    s_mov_b32 s14, 0
POLL_8:
    ds_read_b32 v4, v144
    s_waitcnt lgkmcnt(0)
    v_cmp_ne_u32 vcc, 0, v4
    s_cmp_eq_u64 vcc, -1
    s_cbranch_scc1 POLLD_9
    s_add_u32 s14, s14, 1
    s_cmp_lt_u32 s14, 65536
    s_cbranch_scc1 POLL_8
POLLD_9:
    v_readfirstlane_b32 s12, v4
    s_mov_b64 exec, 1
    s_waitcnt vmcnt(0)
    s_cmp_eq_u32 s12, 1
    s_cbranch_scc0 SLOWST_10
    global_store_dwordx2 v59, v[32:33], s[70:71]
STD_11:
    s_mov_b64 exec, -1
    s_barrier
    s_mov_b32 m0, s48
    s_mov_b32 s14, 0
POLL_12:
    global_load_dwordx4 v[60:63], v2, s[70:71] sc1
    s_waitcnt vmcnt(0)
    v_cmp_eq_u64 s[72:73], s[10:11], v[60:61]
    v_cmp_eq_u64 vcc, s[10:11], v[62:63]
    s_and_b64 vcc, vcc, s[72:73]
    s_cmp_eq_u64 vcc, -1
    s_cbranch_scc1 POLLD_13
    s_add_u32 s14, s14, 1
    s_cmp_lt_u32 s14, 65536
    s_cbranch_scc1 POLL_12
POLLD_13:
    s_cmp_eq_u32 s12, 1
    s_cbranch_scc0 SLOWA_14
ACD_15:
    s_cmp_ge_u32 s5, 30
    s_cbranch_scc1 L_NOCONV
    global_load_lds_dwordx4 v2, s[30:31] sc1
    s_mov_b32 m0, s49
    s_nop 0
    global_load_lds_dwordx4 v2, s[38:39] sc1
    global_load_lds_dwordx4 v2, s[38:39] offset:1024 sc1
    s_mov_b32 m0, s48
    s_nop 0
    global_load_lds_dwordx4 v2, s[30:31] offset:1024 sc1
    s_mov_b32 m0, s50
    s_nop 0
    global_load_lds_dwordx4 v40, s[30:31] sc1
    global_load_lds_dwordx4 v40, s[30:31] offset:1024 sc1
    s_mov_b32 m0, s51
    s_nop 0
    global_load_lds_dwordx4 v40, s[38:39] sc1
    global_load_lds_dwordx4 v40, s[38:39] offset:1024 sc1
    ds_read_b128 v[80:83], v34 offset:0
    ds_read_b128 v[84:87], v34 offset:64
    ds_read_b128 v[88:91], v34 offset:128
    ds_read_b128 v[92:95], v34 offset:192
    s_mov_b32 s75, 0
    s_waitcnt vmcnt(0)
    s_barrier
    s_setprio 2
L_TASK:
    ds_write_b32 v37, v12
    ds_read_b64 v[112:113], v35 offset:0
    ds_read_b64 v[114:115], v35 offset:8
    ds_read_b64 v[116:117], v35 offset:64
    ds_read_b64 v[118:119], v35 offset:72
    ds_read_b64 v[120:121], v35 offset:128
    ds_read_b64 v[122:123], v35 offset:136
    ds_read_b64 v[124:125], v35 offset:192
    ds_read_b64 v[126:127], v35 offset:200
    s_waitcnt lgkmcnt(6)
    v_mfma_f32_16x16x32_bf16 v[76:79], v[80:83], v[112:115], 0
    ds_read_b128 v[96:99], v34 offset:256
    ds_read_b64 v[128:129], v35 offset:256
    ds_read_b64 v[130:131], v35 offset:264
    s_waitcnt lgkmcnt(7)
    v_mfma_f32_16x16x32_bf16 v[76:79], v[84:87], v[116:119], v[76:79]
    ds_read_b128 v[100:103], v34 offset:320
    ds_read_b64 v[132:133], v35 offset:320
    ds_read_b64 v[134:135], v35 offset:328
    s_waitcnt lgkmcnt(8)
    v_mfma_f32_16x16x32_bf16 v[76:79], v[88:91], v[120:123], v[76:79]
    ds_read_b128 v[104:107], v34 offset:384
    ds_read_b64 v[136:137], v35 offset:384
    ds_read_b64 v[138:139], v35 offset:392
    s_waitcnt lgkmcnt(9)
    v_mfma_f32_16x16x32_bf16 v[76:79], v[92:95], v[124:127], v[76:79]
    ds_read_b128 v[108:111], v34 offset:448
    ds_read_b64 v[140:141], v35 offset:448
    ds_read_b64 v[142:143], v35 offset:456
    s_waitcnt lgkmcnt(9)
    v_mfma_f32_16x16x32_bf16 v[76:79], v[96:99], v[128:131], v[76:79]
    ds_read_b128 v[80:83], v34 offset:512
    ds_read_b64 v[144:145], v35 offset:512
    ds_read_b64 v[146:147], v35 offset:520
    s_waitcnt lgkmcnt(9)
    v_mfma_f32_16x16x32_bf16 v[76:79], v[100:103], v[132:135], v[76:79]
    ds_read_b128 v[84:87], v34 offset:576
    ds_read_b64 v[148:149], v35 offset:576
    ds_read_b64 v[150:151], v35 offset:584
    s_waitcnt lgkmcnt(9)
    v_mfma_f32_16x16x32_bf16 v[76:79], v[104:107], v[136:139], v[76:79]
    ds_read_b128 v[88:91], v34 offset:640
    ds_read_b64 v[152:153], v35 offset:640
    ds_read_b64 v[154:155], v35 offset:648
    s_waitcnt lgkmcnt(9)
    v_mfma_f32_16x16x32_bf16 v[76:79], v[108:111], v[140:143], v[76:79]
    ds_read_b128 v[92:95], v34 offset:704
    ds_read_b64 v[156:157], v35 offset:704
    ds_read_b64 v[158:159], v35 offset:712
    s_waitcnt lgkmcnt(9)
    v_mfma_f32_16x16x32_bf16 v[72:75], v[80:83], v[112:115], 0
    ds_read_b128 v[96:99], v34 offset:768
    ds_read_b64 v[160:161], v35 offset:768
    v_mfma_f32_16x16x32_bf16 v[76:79], v[80:83], v[144:147], v[76:79]
    ds_read_b64 v[162:163], v35 offset:776
    s_waitcnt lgkmcnt(9)
    v_mfma_f32_16x16x32_bf16 v[72:75], v[84:87], v[116:119], v[72:75]
    ds_read_b128 v[100:103], v34 offset:832
    ds_read_b64 v[164:165], v35 offset:832
    v_mfma_f32_16x16x32_bf16 v[76:79], v[84:87], v[148:151], v[76:79]
    ds_read_b64 v[166:167], v35 offset:840
    s_waitcnt lgkmcnt(9)
    v_mfma_f32_16x16x32_bf16 v[72:75], v[88:91], v[120:123], v[72:75]
    ds_read_b128 v[104:107], v34 offset:896
    ds_read_b64 v[168:169], v35 offset:896
    v_mfma_f32_16x16x32_bf16 v[76:79], v[88:91], v[152:155], v[76:79]
    ds_read_b64 v[170:171], v35 offset:904
    s_waitcnt lgkmcnt(9)
    v_mfma_f32_16x16x32_bf16 v[72:75], v[92:95], v[124:127], v[72:75]
    ds_read_b128 v[108:111], v34 offset:960
    ds_read_b64 v[172:173], v35 offset:960
    v_mfma_f32_16x16x32_bf16 v[76:79], v[92:95], v[156:159], v[76:79]
    ds_read_b64 v[174:175], v35 offset:968
    s_waitcnt lgkmcnt(9)
    v_mfma_f32_16x16x32_bf16 v[72:75], v[96:99], v[128:131], v[72:75]
    ds_read_b128 v[80:83], v34 offset:1024
    ds_read_b64 v[176:177], v35 offset:1024
    v_mfma_f32_16x16x32_bf16 v[76:79], v[96:99], v[160:163], v[76:79]
    ds_read_b64 v[178:179], v35 offset:1032
    s_waitcnt lgkmcnt(9)
    v_mfma_f32_16x16x32_bf16 v[72:75], v[100:103], v[132:135], v[72:75]
    ds_read_b128 v[84:87], v34 offset:1088
    ds_read_b64 v[180:181], v35 offset:1088
    v_mfma_f32_16x16x32_bf16 v[76:79], v[100:103], v[164:167], v[76:79]
    ds_read_b64 v[182:183], v35 offset:1096
    s_waitcnt lgkmcnt(9)
    v_mfma_f32_16x16x32_bf16 v[72:75], v[104:107], v[136:139], v[72:75]
    ds_read_b128 v[88:91], v34 offset:1152
    ds_read_b64 v[184:185], v35 offset:1152
    v_mfma_f32_16x16x32_bf16 v[76:79], v[104:107], v[168:171], v[76:79]
    ds_read_b64 v[186:187], v35 offset:1160
    s_waitcnt lgkmcnt(9)
    v_mfma_f32_16x16x32_bf16 v[72:75], v[108:111], v[140:143], v[72:75]
    ds_read_b128 v[92:95], v34 offset:1216
    ds_read_b64 v[188:189], v35 offset:1216
    v_mfma_f32_16x16x32_bf16 v[76:79], v[108:111], v[172:175], v[76:79]
    ds_read_b64 v[190:191], v35 offset:1224
    s_waitcnt lgkmcnt(9)
    v_mfma_f32_16x16x32_bf16 v[68:71], v[80:83], v[112:115], 0
    ds_read_b128 v[96:99], v34 offset:1280
    v_mfma_f32_16x16x32_bf16 v[72:75], v[80:83], v[144:147], v[72:75]
    ds_read_b64 v[192:193], v35 offset:1280
    v_mfma_f32_16x16x32_bf16 v[76:79], v[80:83], v[176:179], v[76:79]
    ds_read_b64 v[194:195], v35 offset:1288
    s_waitcnt lgkmcnt(9)
    v_mfma_f32_16x16x32_bf16 v[68:71], v[84:87], v[116:119], v[68:71]
    ds_read_b128 v[100:103], v34 offset:1344
    v_mfma_f32_16x16x32_bf16 v[72:75], v[84:87], v[148:151], v[72:75]
    ds_read_b64 v[196:197], v35 offset:1344
    v_mfma_f32_16x16x32_bf16 v[76:79], v[84:87], v[180:183], v[76:79]
    ds_read_b64 v[198:199], v35 offset:1352
    s_waitcnt lgkmcnt(9)
    v_mfma_f32_16x16x32_bf16 v[68:71], v[88:91], v[120:123], v[68:71]
    ds_read_b128 v[104:107], v34 offset:1408
    v_mfma_f32_16x16x32_bf16 v[72:75], v[88:91], v[152:155], v[72:75]
    ds_read_b64 v[200:201], v35 offset:1408
    v_mfma_f32_16x16x32_bf16 v[76:79], v[88:91], v[184:187], v[76:79]
    ds_read_b64 v[202:203], v35 offset:1416
    s_waitcnt lgkmcnt(9)
    v_mfma_f32_16x16x32_bf16 v[68:71], v[92:95], v[124:127], v[68:71]
    ds_read_b128 v[108:111], v34 offset:1472
    v_mfma_f32_16x16x32_bf16 v[72:75], v[92:95], v[156:159], v[72:75]
    ds_read_b64 v[204:205], v35 offset:1472
    v_mfma_f32_16x16x32_bf16 v[76:79], v[92:95], v[188:191], v[76:79]
    ds_read_b64 v[206:207], v35 offset:1480
    s_waitcnt lgkmcnt(9)
    v_mfma_f32_16x16x32_bf16 v[68:71], v[96:99], v[128:131], v[68:71]
    ds_read_b128 v[80:83], v34 offset:1536
    v_mfma_f32_16x16x32_bf16 v[72:75], v[96:99], v[160:163], v[72:75]
    ds_read_b64 v[208:209], v35 offset:1536
    v_mfma_f32_16x16x32_bf16 v[76:79], v[96:99], v[192:195], v[76:79]
    ds_read_b64 v[210:211], v35 offset:1544
    s_waitcnt lgkmcnt(9)
    v_mfma_f32_16x16x32_bf16 v[68:71], v[100:103], v[132:135], v[68:71]
    ds_read_b128 v[84:87], v34 offset:1600
    v_mfma_f32_16x16x32_bf16 v[72:75], v[100:103], v[164:167], v[72:75]
    ds_read_b64 v[212:213], v35 offset:1600
    v_mfma_f32_16x16x32_bf16 v[76:79], v[100:103], v[196:199], v[76:79]
    ds_read_b64 v[214:215], v35 offset:1608
    s_waitcnt lgkmcnt(9)
    v_mfma_f32_16x16x32_bf16 v[68:71], v[104:107], v[136:139], v[68:71]
    ds_read_b128 v[88:91], v34 offset:1664
    v_mfma_f32_16x16x32_bf16 v[72:75], v[104:107], v[168:171], v[72:75]
    ds_read_b64 v[216:217], v35 offset:1664
    v_mfma_f32_16x16x32_bf16 v[76:79], v[104:107], v[200:203], v[76:79]
    ds_read_b64 v[218:219], v35 offset:1672
    s_waitcnt lgkmcnt(9)
    v_mfma_f32_16x16x32_bf16 v[68:71], v[108:111], v[140:143], v[68:71]
    ds_read_b128 v[92:95], v34 offset:1728
    v_mfma_f32_16x16x32_bf16 v[72:75], v[108:111], v[172:175], v[72:75]
    ds_read_b64 v[220:221], v35 offset:1728
    v_mfma_f32_16x16x32_bf16 v[76:79], v[108:111], v[204:207], v[76:79]
    ds_read_b64 v[222:223], v35 offset:1736
    s_waitcnt lgkmcnt(9)
    v_mfma_f32_16x16x32_bf16 v[64:67], v[80:83], v[112:115], 0
    ds_read_b128 v[96:99], v34 offset:1792
    v_mfma_f32_16x16x32_bf16 v[68:71], v[80:83], v[144:147], v[68:71]
    ds_read_b64 v[224:225], v35 offset:1792
    v_mfma_f32_16x16x32_bf16 v[72:75], v[80:83], v[176:179], v[72:75]
    ds_read_b64 v[226:227], v35 offset:1800
    v_mfma_f32_16x16x32_bf16 v[76:79], v[80:83], v[208:211], v[76:79]
    s_waitcnt lgkmcnt(9)
    v_mfma_f32_16x16x32_bf16 v[64:67], v[84:87], v[116:119], v[64:67]
    ds_read_b128 v[100:103], v34 offset:1856
    v_mfma_f32_16x16x32_bf16 v[68:71], v[84:87], v[148:151], v[68:71]
    ds_read_b64 v[228:229], v35 offset:1856
    v_mfma_f32_16x16x32_bf16 v[72:75], v[84:87], v[180:183], v[72:75]
    ds_read_b64 v[230:231], v35 offset:1864
    v_mfma_f32_16x16x32_bf16 v[76:79], v[84:87], v[212:215], v[76:79]
    s_waitcnt lgkmcnt(9)
    v_mfma_f32_16x16x32_bf16 v[64:67], v[88:91], v[120:123], v[64:67]
    ds_read_b128 v[104:107], v34 offset:1920
    v_mfma_f32_16x16x32_bf16 v[68:71], v[88:91], v[152:155], v[68:71]
    ds_read_b64 v[232:233], v35 offset:1920
    v_mfma_f32_16x16x32_bf16 v[72:75], v[88:91], v[184:187], v[72:75]
    ds_read_b64 v[234:235], v35 offset:1928
    v_mfma_f32_16x16x32_bf16 v[76:79], v[88:91], v[216:219], v[76:79]
    s_waitcnt lgkmcnt(9)
    v_mfma_f32_16x16x32_bf16 v[64:67], v[92:95], v[124:127], v[64:67]
    ds_read_b128 v[108:111], v34 offset:1984
    v_mfma_f32_16x16x32_bf16 v[68:71], v[92:95], v[156:159], v[68:71]
    ds_read_b64 v[236:237], v35 offset:1984
    v_mfma_f32_16x16x32_bf16 v[72:75], v[92:95], v[188:191], v[72:75]
    ds_read_b64 v[238:239], v35 offset:1992
    v_mfma_f32_16x16x32_bf16 v[76:79], v[92:95], v[220:223], v[76:79]
    s_waitcnt lgkmcnt(9)
    v_mfma_f32_16x16x32_bf16 v[64:67], v[96:99], v[128:131], v[64:67]
    ds_read_b128 v[80:83], v34 offset:2048
    v_mfma_f32_16x16x32_bf16 v[68:71], v[96:99], v[160:163], v[68:71]
    ds_read_b64 v[112:113], v35 offset:2048
    v_mfma_f32_16x16x32_bf16 v[72:75], v[96:99], v[192:195], v[72:75]
    ds_read_b64 v[114:115], v35 offset:2056
    v_mfma_f32_16x16x32_bf16 v[76:79], v[96:99], v[224:227], v[76:79]
    s_waitcnt lgkmcnt(9)
    v_mfma_f32_16x16x32_bf16 v[64:67], v[100:103], v[132:135], v[64:67]
    ds_read_b128 v[84:87], v34 offset:2112
    v_mfma_f32_16x16x32_bf16 v[68:71], v[100:103], v[164:167], v[68:71]
    ds_read_b64 v[116:117], v35 offset:2112
    v_mfma_f32_16x16x32_bf16 v[72:75], v[100:103], v[196:199], v[72:75]
    ds_read_b64 v[118:119], v35 offset:2120
    v_mfma_f32_16x16x32_bf16 v[76:79], v[100:103], v[228:231], v[76:79]
    s_waitcnt lgkmcnt(9)
    v_mfma_f32_16x16x32_bf16 v[64:67], v[104:107], v[136:139], v[64:67]
    ds_read_b128 v[88:91], v34 offset:2176
    v_mfma_f32_16x16x32_bf16 v[68:71], v[104:107], v[168:171], v[68:71]
    ds_read_b64 v[120:121], v35 offset:2176
    v_mfma_f32_16x16x32_bf16 v[72:75], v[104:107], v[200:203], v[72:75]
    ds_read_b64 v[122:123], v35 offset:2184
    v_mfma_f32_16x16x32_bf16 v[76:79], v[104:107], v[232:235], v[76:79]
    s_waitcnt lgkmcnt(9)
    v_mfma_f32_16x16x32_bf16 v[64:67], v[108:111], v[140:143], v[64:67]
    ds_read_b128 v[92:95], v34 offset:2240
    v_mfma_f32_16x16x32_bf16 v[68:71], v[108:111], v[172:175], v[68:71]
    ds_read_b64 v[124:125], v35 offset:2240
    v_mfma_f32_16x16x32_bf16 v[72:75], v[108:111], v[204:207], v[72:75]
    ds_read_b64 v[126:127], v35 offset:2248
    v_mfma_f32_16x16x32_bf16 v[76:79], v[108:111], v[236:239], v[76:79]
    s_cmp_eq_u32 s53, 1
    s_cbranch_scc1 L_EPI
    s_waitcnt lgkmcnt(9)
    v_mfma_f32_16x16x32_bf16 v[64:67], v[80:83], v[144:147], v[64:67]
    ds_read_b128 v[96:99], v34 offset:2304
    v_mfma_f32_16x16x32_bf16 v[68:71], v[80:83], v[176:179], v[68:71]
    ds_read_b64 v[128:129], v35 offset:2304
    v_mfma_f32_16x16x32_bf16 v[72:75], v[80:83], v[208:211], v[72:75]
    ds_read_b64 v[130:131], v35 offset:2312
    v_mfma_f32_16x16x32_bf16 v[76:79], v[80:83], v[112:115], v[76:79]
    s_waitcnt lgkmcnt(9)
    v_mfma_f32_16x16x32_bf16 v[64:67], v[84:87], v[148:151], v[64:67]
    ds_read_b128 v[100:103], v34 offset:2368
    v_mfma_f32_16x16x32_bf16 v[68:71], v[84:87], v[180:183], v[68:71]
    ds_read_b64 v[132:133], v35 offset:2368
    v_mfma_f32_16x16x32_bf16 v[72:75], v[84:87], v[212:215], v[72:75]
    ds_read_b64 v[134:135], v35 offset:2376
    v_mfma_f32_16x16x32_bf16 v[76:79], v[84:87], v[116:119], v[76:79]
    s_waitcnt lgkmcnt(9)
    v_mfma_f32_16x16x32_bf16 v[64:67], v[88:91], v[152:155], v[64:67]
    ds_read_b128 v[104:107], v34 offset:2432
    v_mfma_f32_16x16x32_bf16 v[68:71], v[88:91], v[184:187], v[68:71]
    ds_read_b64 v[136:137], v35 offset:2432
    v_mfma_f32_16x16x32_bf16 v[72:75], v[88:91], v[216:219], v[72:75]
    ds_read_b64 v[138:139], v35 offset:2440
    v_mfma_f32_16x16x32_bf16 v[76:79], v[88:91], v[120:123], v[76:79]
    s_waitcnt lgkmcnt(9)
    v_mfma_f32_16x16x32_bf16 v[64:67], v[92:95], v[156:159], v[64:67]
    ds_read_b128 v[108:111], v34 offset:2496
    v_mfma_f32_16x16x32_bf16 v[68:71], v[92:95], v[188:191], v[68:71]
    ds_read_b64 v[140:141], v35 offset:2496
    v_mfma_f32_16x16x32_bf16 v[72:75], v[92:95], v[220:223], v[72:75]
    ds_read_b64 v[142:143], v35 offset:2504
    v_mfma_f32_16x16x32_bf16 v[76:79], v[92:95], v[124:127], v[76:79]
    s_waitcnt lgkmcnt(9)
    v_mfma_f32_16x16x32_bf16 v[64:67], v[96:99], v[160:163], v[64:67]
    ds_read_b128 v[80:83], v34 offset:2560
    v_mfma_f32_16x16x32_bf16 v[68:71], v[96:99], v[192:195], v[68:71]
    ds_read_b64 v[144:145], v35 offset:2560
    v_mfma_f32_16x16x32_bf16 v[72:75], v[96:99], v[224:227], v[72:75]
    ds_read_b64 v[146:147], v35 offset:2568
    v_mfma_f32_16x16x32_bf16 v[76:79], v[96:99], v[128:131], v[76:79]
    s_waitcnt lgkmcnt(9)
    v_mfma_f32_16x16x32_bf16 v[64:67], v[100:103], v[164:167], v[64:67]
    ds_read_b128 v[84:87], v34 offset:2624
    v_mfma_f32_16x16x32_bf16 v[68:71], v[100:103], v[196:199], v[68:71]
    ds_read_b64 v[148:149], v35 offset:2624
    v_mfma_f32_16x16x32_bf16 v[72:75], v[100:103], v[228:231], v[72:75]
    ds_read_b64 v[150:151], v35 offset:2632
    v_mfma_f32_16x16x32_bf16 v[76:79], v[100:103], v[132:135], v[76:79]
    s_waitcnt lgkmcnt(9)
    v_mfma_f32_16x16x32_bf16 v[64:67], v[104:107], v[168:171], v[64:67]
    ds_read_b128 v[88:91], v34 offset:2688
    v_mfma_f32_16x16x32_bf16 v[68:71], v[104:107], v[200:203], v[68:71]
    ds_read_b64 v[152:153], v35 offset:2688
    v_mfma_f32_16x16x32_bf16 v[72:75], v[104:107], v[232:235], v[72:75]
    ds_read_b64 v[154:155], v35 offset:2696
    v_mfma_f32_16x16x32_bf16 v[76:79], v[104:107], v[136:139], v[76:79]
    s_waitcnt lgkmcnt(9)
    v_mfma_f32_16x16x32_bf16 v[64:67], v[108:111], v[172:175], v[64:67]
    ds_read_b128 v[92:95], v34 offset:2752
    v_mfma_f32_16x16x32_bf16 v[68:71], v[108:111], v[204:207], v[68:71]
    ds_read_b64 v[156:157], v35 offset:2752
    v_mfma_f32_16x16x32_bf16 v[72:75], v[108:111], v[236:239], v[72:75]
    ds_read_b64 v[158:159], v35 offset:2760
    v_mfma_f32_16x16x32_bf16 v[76:79], v[108:111], v[140:143], v[76:79]
    s_waitcnt lgkmcnt(9)
    v_mfma_f32_16x16x32_bf16 v[64:67], v[80:83], v[176:179], v[64:67]
    ds_read_b128 v[96:99], v34 offset:2816
    v_mfma_f32_16x16x32_bf16 v[68:71], v[80:83], v[208:211], v[68:71]
    ds_read_b64 v[160:161], v35 offset:2816
    v_mfma_f32_16x16x32_bf16 v[72:75], v[80:83], v[112:115], v[72:75]
    ds_read_b64 v[162:163], v35 offset:2824
    v_mfma_f32_16x16x32_bf16 v[76:79], v[80:83], v[144:147], v[76:79]
    s_waitcnt lgkmcnt(9)
    v_mfma_f32_16x16x32_bf16 v[64:67], v[84:87], v[180:183], v[64:67]
    ds_read_b128 v[100:103], v34 offset:2880
    v_mfma_f32_16x16x32_bf16 v[68:71], v[84:87], v[212:215], v[68:71]
    ds_read_b64 v[164:165], v35 offset:2880
    v_mfma_f32_16x16x32_bf16 v[72:75], v[84:87], v[116:119], v[72:75]
    ds_read_b64 v[166:167], v35 offset:2888
    v_mfma_f32_16x16x32_bf16 v[76:79], v[84:87], v[148:151], v[76:79]
    s_waitcnt lgkmcnt(9)
    v_mfma_f32_16x16x32_bf16 v[64:67], v[88:91], v[184:187], v[64:67]
    ds_read_b128 v[104:107], v34 offset:2944
    v_mfma_f32_16x16x32_bf16 v[68:71], v[88:91], v[216:219], v[68:71]
    ds_read_b64 v[168:169], v35 offset:2944
    v_mfma_f32_16x16x32_bf16 v[72:75], v[88:91], v[120:123], v[72:75]
    ds_read_b64 v[170:171], v35 offset:2952
    v_mfma_f32_16x16x32_bf16 v[76:79], v[88:91], v[152:155], v[76:79]
    s_waitcnt lgkmcnt(9)
    v_mfma_f32_16x16x32_bf16 v[64:67], v[92:95], v[188:191], v[64:67]
    ds_read_b128 v[108:111], v34 offset:3008
    v_mfma_f32_16x16x32_bf16 v[68:71], v[92:95], v[220:223], v[68:71]
    ds_read_b64 v[172:173], v35 offset:3008
    v_mfma_f32_16x16x32_bf16 v[72:75], v[92:95], v[124:127], v[72:75]
    ds_read_b64 v[174:175], v35 offset:3016
    v_mfma_f32_16x16x32_bf16 v[76:79], v[92:95], v[156:159], v[76:79]
    s_waitcnt lgkmcnt(9)
    v_mfma_f32_16x16x32_bf16 v[64:67], v[96:99], v[192:195], v[64:67]
    ds_read_b128 v[80:83], v34 offset:3072
    v_mfma_f32_16x16x32_bf16 v[68:71], v[96:99], v[224:227], v[68:71]
    ds_read_b64 v[176:177], v35 offset:3072
    v_mfma_f32_16x16x32_bf16 v[72:75], v[96:99], v[128:131], v[72:75]
    ds_read_b64 v[178:179], v35 offset:3080
    v_mfma_f32_16x16x32_bf16 v[76:79], v[96:99], v[160:163], v[76:79]
    s_waitcnt lgkmcnt(9)
    v_mfma_f32_16x16x32_bf16 v[64:67], v[100:103], v[196:199], v[64:67]
    ds_read_b128 v[84:87], v34 offset:3136
    v_mfma_f32_16x16x32_bf16 v[68:71], v[100:103], v[228:231], v[68:71]
    ds_read_b64 v[180:181], v35 offset:3136
    v_mfma_f32_16x16x32_bf16 v[72:75], v[100:103], v[132:135], v[72:75]
    ds_read_b64 v[182:183], v35 offset:3144
    v_mfma_f32_16x16x32_bf16 v[76:79], v[100:103], v[164:167], v[76:79]
    s_waitcnt lgkmcnt(9)
    v_mfma_f32_16x16x32_bf16 v[64:67], v[104:107], v[200:203], v[64:67]
    ds_read_b128 v[88:91], v34 offset:3200
    v_mfma_f32_16x16x32_bf16 v[68:71], v[104:107], v[232:235], v[68:71]
    ds_read_b64 v[184:185], v35 offset:3200
    v_mfma_f32_16x16x32_bf16 v[72:75], v[104:107], v[136:139], v[72:75]
    ds_read_b64 v[186:187], v35 offset:3208
    v_mfma_f32_16x16x32_bf16 v[76:79], v[104:107], v[168:171], v[76:79]
    s_waitcnt lgkmcnt(9)
    v_mfma_f32_16x16x32_bf16 v[64:67], v[108:111], v[204:207], v[64:67]
    ds_read_b128 v[92:95], v34 offset:3264
    v_mfma_f32_16x16x32_bf16 v[68:71], v[108:111], v[236:239], v[68:71]
    ds_read_b64 v[188:189], v35 offset:3264
    v_mfma_f32_16x16x32_bf16 v[72:75], v[108:111], v[140:143], v[72:75]
    ds_read_b64 v[190:191], v35 offset:3272
    v_mfma_f32_16x16x32_bf16 v[76:79], v[108:111], v[172:175], v[76:79]
    s_waitcnt lgkmcnt(9)
    v_mfma_f32_16x16x32_bf16 v[64:67], v[80:83], v[208:211], v[64:67]
    ds_read_b128 v[96:99], v34 offset:3328
    v_mfma_f32_16x16x32_bf16 v[68:71], v[80:83], v[112:115], v[68:71]
    ds_read_b64 v[192:193], v35 offset:3328
    v_mfma_f32_16x16x32_bf16 v[72:75], v[80:83], v[144:147], v[72:75]
    ds_read_b64 v[194:195], v35 offset:3336
    v_mfma_f32_16x16x32_bf16 v[76:79], v[80:83], v[176:179], v[76:79]
    s_waitcnt lgkmcnt(9)
    v_mfma_f32_16x16x32_bf16 v[64:67], v[84:87], v[212:215], v[64:67]
    ds_read_b128 v[100:103], v34 offset:3392
    v_mfma_f32_16x16x32_bf16 v[68:71], v[84:87], v[116:119], v[68:71]
    ds_read_b64 v[196:197], v35 offset:3392
    v_mfma_f32_16x16x32_bf16 v[72:75], v[84:87], v[148:151], v[72:75]
    ds_read_b64 v[198:199], v35 offset:3400
    v_mfma_f32_16x16x32_bf16 v[76:79], v[84:87], v[180:183], v[76:79]
    s_waitcnt lgkmcnt(9)
    v_mfma_f32_16x16x32_bf16 v[64:67], v[88:91], v[216:219], v[64:67]
    ds_read_b128 v[104:107], v34 offset:3456
    v_mfma_f32_16x16x32_bf16 v[68:71], v[88:91], v[120:123], v[68:71]
    ds_read_b64 v[200:201], v35 offset:3456
    v_mfma_f32_16x16x32_bf16 v[72:75], v[88:91], v[152:155], v[72:75]
    ds_read_b64 v[202:203], v35 offset:3464
    v_mfma_f32_16x16x32_bf16 v[76:79], v[88:91], v[184:187], v[76:79]
    s_waitcnt lgkmcnt(9)
    v_mfma_f32_16x16x32_bf16 v[64:67], v[92:95], v[220:223], v[64:67]
    ds_read_b128 v[108:111], v34 offset:3520
    v_mfma_f32_16x16x32_bf16 v[68:71], v[92:95], v[124:127], v[68:71]
    ds_read_b64 v[204:205], v35 offset:3520
    v_mfma_f32_16x16x32_bf16 v[72:75], v[92:95], v[156:159], v[72:75]
    ds_read_b64 v[206:207], v35 offset:3528
    v_mfma_f32_16x16x32_bf16 v[76:79], v[92:95], v[188:191], v[76:79]
    s_waitcnt lgkmcnt(9)
    v_mfma_f32_16x16x32_bf16 v[64:67], v[96:99], v[224:227], v[64:67]
    ds_read_b128 v[80:83], v34 offset:3584
    v_mfma_f32_16x16x32_bf16 v[68:71], v[96:99], v[128:131], v[68:71]
    ds_read_b64 v[208:209], v35 offset:3584
    v_mfma_f32_16x16x32_bf16 v[72:75], v[96:99], v[160:163], v[72:75]
    ds_read_b64 v[210:211], v35 offset:3592
    v_mfma_f32_16x16x32_bf16 v[76:79], v[96:99], v[192:195], v[76:79]
    s_waitcnt lgkmcnt(9)
    v_mfma_f32_16x16x32_bf16 v[64:67], v[100:103], v[228:231], v[64:67]
    ds_read_b128 v[84:87], v34 offset:3648
    v_mfma_f32_16x16x32_bf16 v[68:71], v[100:103], v[132:135], v[68:71]
    ds_read_b64 v[212:213], v35 offset:3648
    v_mfma_f32_16x16x32_bf16 v[72:75], v[100:103], v[164:167], v[72:75]
    ds_read_b64 v[214:215], v35 offset:3656
    v_mfma_f32_16x16x32_bf16 v[76:79], v[100:103], v[196:199], v[76:79]
    s_waitcnt lgkmcnt(9)
    v_mfma_f32_16x16x32_bf16 v[64:67], v[104:107], v[232:235], v[64:67]
    ds_read_b128 v[88:91], v34 offset:3712
    v_mfma_f32_16x16x32_bf16 v[68:71], v[104:107], v[136:139], v[68:71]
    ds_read_b64 v[216:217], v35 offset:3712
    v_mfma_f32_16x16x32_bf16 v[72:75], v[104:107], v[168:171], v[72:75]
    ds_read_b64 v[218:219], v35 offset:3720
    v_mfma_f32_16x16x32_bf16 v[76:79], v[104:107], v[200:203], v[76:79]
    s_waitcnt lgkmcnt(9)
    v_mfma_f32_16x16x32_bf16 v[64:67], v[108:111], v[236:239], v[64:67]
    ds_read_b128 v[92:95], v34 offset:3776
    v_mfma_f32_16x16x32_bf16 v[68:71], v[108:111], v[140:143], v[68:71]
    ds_read_b64 v[220:221], v35 offset:3776
    v_mfma_f32_16x16x32_bf16 v[72:75], v[108:111], v[172:175], v[72:75]
    ds_read_b64 v[222:223], v35 offset:3784
    v_mfma_f32_16x16x32_bf16 v[76:79], v[108:111], v[204:207], v[76:79]
    s_waitcnt lgkmcnt(9)
    v_mfma_f32_16x16x32_bf16 v[64:67], v[80:83], v[112:115], v[64:67]
    ds_read_b128 v[96:99], v34 offset:3840
    v_mfma_f32_16x16x32_bf16 v[68:71], v[80:83], v[144:147], v[68:71]
    ds_read_b64 v[224:225], v35 offset:3840
    v_mfma_f32_16x16x32_bf16 v[72:75], v[80:83], v[176:179], v[72:75]
    ds_read_b64 v[226:227], v35 offset:3848
    v_mfma_f32_16x16x32_bf16 v[76:79], v[80:83], v[208:211], v[76:79]
    s_waitcnt lgkmcnt(9)
    v_mfma_f32_16x16x32_bf16 v[64:67], v[84:87], v[116:119], v[64:67]
    ds_read_b128 v[100:103], v34 offset:3904
    v_mfma_f32_16x16x32_bf16 v[68:71], v[84:87], v[148:151], v[68:71]
    ds_read_b64 v[228:229], v35 offset:3904
    v_mfma_f32_16x16x32_bf16 v[72:75], v[84:87], v[180:183], v[72:75]
    ds_read_b64 v[230:231], v35 offset:3912
    v_mfma_f32_16x16x32_bf16 v[76:79], v[84:87], v[212:215], v[76:79]
    s_waitcnt lgkmcnt(9)
    v_mfma_f32_16x16x32_bf16 v[64:67], v[88:91], v[120:123], v[64:67]
    ds_read_b128 v[104:107], v34 offset:3968
    v_mfma_f32_16x16x32_bf16 v[68:71], v[88:91], v[152:155], v[68:71]
    ds_read_b64 v[232:233], v35 offset:3968
    v_mfma_f32_16x16x32_bf16 v[72:75], v[88:91], v[184:187], v[72:75]
    ds_read_b64 v[234:235], v35 offset:3976
    v_mfma_f32_16x16x32_bf16 v[76:79], v[88:91], v[216:219], v[76:79]
    s_waitcnt lgkmcnt(9)
    v_mfma_f32_16x16x32_bf16 v[64:67], v[92:95], v[124:127], v[64:67]
    ds_read_b128 v[108:111], v34 offset:4032
    v_mfma_f32_16x16x32_bf16 v[68:71], v[92:95], v[156:159], v[68:71]
    ds_read_b64 v[236:237], v35 offset:4032
    v_mfma_f32_16x16x32_bf16 v[72:75], v[92:95], v[188:191], v[72:75]
    ds_read_b64 v[238:239], v35 offset:4040
    v_mfma_f32_16x16x32_bf16 v[76:79], v[92:95], v[220:223], v[76:79]
    s_waitcnt lgkmcnt(9)
    v_mfma_f32_16x16x32_bf16 v[64:67], v[96:99], v[128:131], v[64:67]
    v_mfma_f32_16x16x32_bf16 v[68:71], v[96:99], v[160:163], v[68:71]
    v_mfma_f32_16x16x32_bf16 v[72:75], v[96:99], v[192:195], v[72:75]
    v_mfma_f32_16x16x32_bf16 v[76:79], v[96:99], v[224:227], v[76:79]
    s_waitcnt lgkmcnt(6)
    v_mfma_f32_16x16x32_bf16 v[64:67], v[100:103], v[132:135], v[64:67]
    v_mfma_f32_16x16x32_bf16 v[68:71], v[100:103], v[164:167], v[68:71]
    v_mfma_f32_16x16x32_bf16 v[72:75], v[100:103], v[196:199], v[72:75]
    v_mfma_f32_16x16x32_bf16 v[76:79], v[100:103], v[228:231], v[76:79]
    s_waitcnt lgkmcnt(3)
    v_mfma_f32_16x16x32_bf16 v[64:67], v[104:107], v[136:139], v[64:67]
    v_mfma_f32_16x16x32_bf16 v[68:71], v[104:107], v[168:171], v[68:71]
    v_mfma_f32_16x16x32_bf16 v[72:75], v[104:107], v[200:203], v[72:75]
    v_mfma_f32_16x16x32_bf16 v[76:79], v[104:107], v[232:235], v[76:79]
    s_waitcnt lgkmcnt(0)
    v_mfma_f32_16x16x32_bf16 v[64:67], v[108:111], v[140:143], v[64:67]
    v_mfma_f32_16x16x32_bf16 v[68:71], v[108:111], v[172:175], v[68:71]
    v_mfma_f32_16x16x32_bf16 v[72:75], v[108:111], v[204:207], v[72:75]
    v_mfma_f32_16x16x32_bf16 v[76:79], v[108:111], v[236:239], v[76:79]
    s_nop 0
L_EPI:
    s_nop 4
    v_cvt_pk_bf16_f32 v240, v64, v65
    v_cvt_pk_bf16_f32 v241, v66, v67
    global_store_dword v36, v240, s[40:41] offset:0
    global_store_dword v36, v241, s[40:41] offset:64
    v_cvt_pk_bf16_f32 v242, v68, v69
    v_cvt_pk_bf16_f32 v243, v70, v71
    global_store_dword v36, v242, s[40:41] offset:512
    global_store_dword v36, v243, s[40:41] offset:576
    v_cvt_pk_bf16_f32 v244, v72, v73
    v_cvt_pk_bf16_f32 v245, v74, v75
    global_store_dword v36, v244, s[40:41] offset:1024
    global_store_dword v36, v245, s[40:41] offset:1088
    v_cvt_pk_bf16_f32 v246, v76, v77
    v_cvt_pk_bf16_f32 v247, v78, v79
    global_store_dword v36, v246, s[40:41] offset:1536
    global_store_dword v36, v247, s[40:41] offset:1600
    s_cmp_lt_u32 s75, s53
    s_cbranch_scc0 L_CONVD
    s_mov_b32 s75, 1
    v_add_u32 v35, 9792, v35
    v_add_u32 v34, 9792, v34
    v_add_u32 v37, 9792, v37
    v_add_u32 v36, 4096, v36
    s_waitcnt lgkmcnt(0)
    ds_read_b128 v[80:83], v34 offset:0
    ds_read_b128 v[84:87], v34 offset:64
    ds_read_b128 v[88:91], v34 offset:128
    ds_read_b128 v[92:95], v34 offset:192
    s_branch L_TASK
L_CONVD:
    s_setprio 3
    s_add_u32 s74, s7, 120320
    s_mov_b32 m0, s74
    s_mov_b64 exec, 1
    s_waitcnt vmcnt(0) lgkmcnt(0)
    s_cmp_eq_u32 s12, 1
    s_cbranch_scc0 SLOWST_16
    global_store_dwordx2 v59, v[32:33], s[70:71] offset:1024
STD_17:
    s_mov_b64 exec, -1
    s_mov_b32 s14, 0
POLL_18:
    global_load_dwordx4 v[60:63], v2, s[70:71] offset:1024 sc1
    s_waitcnt vmcnt(0)
    v_cmp_eq_u64 s[72:73], s[10:11], v[60:61]
    v_cmp_eq_u64 vcc, s[10:11], v[62:63]
    s_and_b64 vcc, vcc, s[72:73]
    s_cmp_eq_u64 vcc, -1
    s_cbranch_scc1 POLLD_19
    s_add_u32 s14, s14, 1
    s_cmp_lt_u32 s14, 65536
    s_cbranch_scc1 POLL_18
POLLD_19:
    s_cmp_eq_u32 s12, 1
    s_cbranch_scc0 SLOWA_20
ACD_21:
    global_load_lds_dwordx4 v41, s[18:19] sc1
    s_add_u32 s74, s74, 4096
    s_mov_b32 m0, s74
    s_add_u32 s74, s8, 120320
    global_load_lds_dwordx4 v42, s[18:19] sc1
    s_mov_b32 m0, s74
    s_nop 0
    global_load_lds_dwordx4 v43, s[18:19] sc1
    s_min_u32 s76, s5, 26
    s_mul_i32 s74, s76, 81920
    s_mul_i32 s75, s4, 160
    s_add_u32 s74, s74, s75
    v_add_u32 v47, s74, v8
    v_add_u32 v48, s74, v9
    v_add_u32 v49, s74, v10
    s_waitcnt vmcnt(0)
    s_barrier
    s_setprio 0
    s_add_u32 s74, s7, 0
    s_mov_b32 m0, s74
    s_add_u32 s74, s74, 4096
    global_load_lds_dwordx4 v47, s[36:37]
    s_mov_b32 m0, s74
    s_add_u32 s74, s8, 0
    global_load_lds_dwordx4 v48, s[36:37]
    s_mov_b32 m0, s74
    s_nop 0
    global_load_lds_dwordx4 v49, s[36:37]
    v_and_b32 v3, 1, v1
    v_cmp_eq_u32 s[72:73], 1, v3
    v_and_b32 v6, 0x30, v1
    s_lshl_b32 s74, s3, 8
    v_add_u32 v65, s74, v2
    s_mov_b32 s9, 0x3f80
    v_lshlrev_b32 v7, 2, v1
    v_lshlrev_b32 v66, 1, v1
    v_add_u32 v66, 152896, v66
    v_lshlrev_b32 v67, 7, v3
    v_add_u32 v67, v67, v6
    v_add_u32 v67, 152896, v67
    v_add_u32 v80, 6144, v2
    v_add_u32 v81, 12288, v2
    v_add_u32 v82, 18432, v2
    s_add_u32 s64, s68, 0x800
    s_addc_u32 s65, s69, 0
    s_barrier
    v_lshrrev_b32 v4, 4, v1
    v_bfe_u32 v5, v1, 2, 2
    v_and_b32 v40, 3, v1
    v_lshlrev_b32 v40, 3, v40
    s_lshl_b32 s74, s3, 5
    s_add_u32 s74, s74, 78336
    v_add_u32 v40, s74, v40
    v_mov_b32 v71, 80
    v_cmp_eq_u32 s[78:79], 3, v5
    v_add_u32 v68, 0, v4
    v_mul_u32_u24 v69, 11, v68
    v_lshrrev_b32 v69, 5, v69
    v_mul_u32_u24 v70, 3, v69
    v_sub_u32 v68, v68, v70
    v_mul_u32_u24 v68, 7, v68
    v_add_u32 v68, v68, v5
    v_mul_u32_u24 v69, 20, v69
    v_add_u32 v70, 0, v68
    v_cmp_le_u32 vcc, 20, v70
    v_add_u32 v70, v70, v69
    s_nop 0
    v_cndmask_b32 v70, v70, v71, vcc
    v_lshl_add_u32 v50, v70, 7, v40
    v_add_u32 v70, 4, v68
    v_cmp_le_u32 vcc, 20, v70
    v_add_u32 v70, v70, v69
    s_or_b64 vcc, vcc, s[78:79]
    v_cndmask_b32 v70, v70, v71, vcc
    v_lshl_add_u32 v51, v70, 7, v40
    v_add_u32 v68, 4, v4
    v_mul_u32_u24 v69, 11, v68
    v_lshrrev_b32 v69, 5, v69
    v_mul_u32_u24 v70, 3, v69
    v_sub_u32 v68, v68, v70
    v_mul_u32_u24 v68, 7, v68
    v_add_u32 v68, v68, v5
    v_mul_u32_u24 v69, 20, v69
    v_add_u32 v70, 0, v68
    v_cmp_le_u32 vcc, 20, v70
    v_add_u32 v70, v70, v69
    s_nop 0
    v_cndmask_b32 v70, v70, v71, vcc
    v_lshl_add_u32 v52, v70, 7, v40
    v_add_u32 v70, 4, v68
    v_cmp_le_u32 vcc, 20, v70
    v_add_u32 v70, v70, v69
    s_or_b64 vcc, vcc, s[78:79]
    v_cndmask_b32 v70, v70, v71, vcc
    v_lshl_add_u32 v53, v70, 7, v40
    v_add_u32 v68, 8, v4
    v_mul_u32_u24 v69, 11, v68
    v_lshrrev_b32 v69, 5, v69
    v_mul_u32_u24 v70, 3, v69
    v_sub_u32 v68, v68, v70
    v_mul_u32_u24 v68, 7, v68
    v_add_u32 v68, v68, v5
    v_mul_u32_u24 v69, 20, v69
    v_add_u32 v70, 0, v68
    v_cmp_le_u32 vcc, 20, v70
    v_add_u32 v70, v70, v69
    s_nop 0
    v_cndmask_b32 v70, v70, v71, vcc
    v_lshl_add_u32 v54, v70, 7, v40
    v_add_u32 v70, 4, v68
    v_cmp_le_u32 vcc, 20, v70
    v_add_u32 v70, v70, v69
    s_or_b64 vcc, vcc, s[78:79]
    v_cndmask_b32 v70, v70, v71, vcc
    v_lshl_add_u32 v55, v70, 7, v40
    s_waitcnt vmcnt(0) lgkmcnt(0)
    global_load_dword v60, v7, s[70:71] offset:2048 sc1
    s_setprio 3
    s_barrier
    global_load_dword v64, v7, s[70:71] offset:2048 sc1
    ds_read_b64_tr_b16 v[84:85], v50
    ds_read_b64_tr_b16 v[96:97], v50 offset:10368
    ds_read_b64_tr_b16 v[86:87], v51
    ds_read_b64_tr_b16 v[98:99], v51 offset:10368
    ds_read_b64_tr_b16 v[88:89], v52
    ds_read_b64_tr_b16 v[100:101], v52 offset:10368
    ds_read_b64_tr_b16 v[90:91], v53
    ds_read_b64_tr_b16 v[102:103], v53 offset:10368
    ds_read_b64_tr_b16 v[92:93], v54
    ds_read_b64_tr_b16 v[104:105], v54 offset:10368
    ds_read_b64_tr_b16 v[94:95], v55
    ds_read_b64_tr_b16 v[106:107], v55 offset:10368
    s_mov_b32 s14, 0
L_22:
    s_waitcnt vmcnt(0)
    v_cmp_ne_u32 vcc, 0, v64
    s_cmp_eq_u64 vcc, -1
    s_cbranch_scc1 L_23
    global_load_dword v64, v7, s[70:71] offset:2048 sc1
    s_add_u32 s14, s14, 1
    s_cmp_lt_u32 s14, 65536
    s_cbranch_scc1 L_22
    s_waitcnt vmcnt(0)
L_23:
    v_mov_b32 v3, v64
    s_nop 0
    v_max_u32_dpp v3, v64, v64 row_shr:1 row_mask:0xf bank_mask:0xf
    s_nop 1
    v_max_u32_dpp v3, v3, v3 row_shr:2 row_mask:0xf bank_mask:0xf
    s_nop 1
    v_max_u32_dpp v3, v3, v3 row_shr:4 row_mask:0xf bank_mask:0xf
    s_nop 1
    v_max_u32_dpp v3, v3, v3 row_shr:8 row_mask:0xf bank_mask:0xf
    s_nop 1
    v_max_u32_dpp v3, v3, v3 row_bcast:15 row_mask:0xa bank_mask:0xf
    s_nop 1
    v_max_u32_dpp v3, v3, v3 row_bcast:31 row_mask:0xc bank_mask:0xf
    s_nop 0
    v_readlane_b32 s78, v3, 63
    s_nop 1
    v_cmp_eq_u32 vcc, s78, v64
    s_ff1_i32_b64 s80, vcc
    s_nop 0
    v_cndmask_b32 v64, v64, 0, vcc
    v_mov_b32 v3, v64
    s_nop 0
    v_max_u32_dpp v3, v64, v64 row_shr:1 row_mask:0xf bank_mask:0xf
    s_nop 1
    v_max_u32_dpp v3, v3, v3 row_shr:2 row_mask:0xf bank_mask:0xf
    s_nop 1
    v_max_u32_dpp v3, v3, v3 row_shr:4 row_mask:0xf bank_mask:0xf
    s_nop 1
    v_max_u32_dpp v3, v3, v3 row_shr:8 row_mask:0xf bank_mask:0xf
    s_nop 1
    v_max_u32_dpp v3, v3, v3 row_bcast:15 row_mask:0xa bank_mask:0xf
    s_nop 1
    v_max_u32_dpp v3, v3, v3 row_bcast:31 row_mask:0xc bank_mask:0xf
    s_nop 0
    v_readlane_b32 s79, v3, 63
    s_nop 1
    v_cmp_eq_u32 vcc, s79, v64
    s_ff1_i32_b64 s81, vcc
    s_cmp_ge_u32 s5, 27
    s_cbranch_scc1 L_NOMOE
    s_lshr_b32 s6, s80, 1
    s_mul_i32 s6, s6, 640
    s_mul_i32 s74, s80, 192
    s_add_u32 s74, s74, s6
    s_lshr_b32 s6, s81, 1
    s_mul_i32 s6, s6, 640
    s_mul_i32 s75, s81, 192
    s_add_u32 s75, s75, s6
    v_mov_b32 v4, s74
    v_mov_b32 v5, s75
    v_cndmask_b32 v4, v4, v5, s[72:73]
    v_add_u32 v4, v4, v6
    s_mov_b32 s14, 0
POLL_24:
    global_load_dwordx4 v[68:71], v4, s[20:21] offset:0 sc1
    global_load_dwordx4 v[72:75], v4, s[20:21] offset:64 sc1
    global_load_dwordx4 v[76:79], v4, s[20:21] offset:128 sc1
    s_waitcnt vmcnt(0)
    v_and_b32 v3, v71, v75
    v_and_b32 v3, v3, v79
    v_lshrrev_b32 v3, 16, v3
    v_cmp_eq_u32 vcc, s9, v3
    s_cmp_eq_u64 vcc, -1
    s_cbranch_scc1 POLLD_25
    s_add_u32 s14, s14, 1
    s_cmp_lt_u32 s14, 65536
    s_cbranch_scc1 POLL_24
POLLD_25:
    s_waitcnt lgkmcnt(0)
    v_mfma_f32_16x16x32_bf16 v[148:151], v[68:71], v[84:87], 0
    v_mfma_f32_16x16x32_bf16 v[152:155], v[68:71], v[96:99], 0
    v_mfma_f32_16x16x32_bf16 v[148:151], v[72:75], v[88:91], v[148:151]
    v_mfma_f32_16x16x32_bf16 v[152:155], v[72:75], v[100:103], v[152:155]
    v_mfma_f32_16x16x32_bf16 v[148:151], v[76:79], v[92:95], v[148:151]
    v_mfma_f32_16x16x32_bf16 v[152:155], v[76:79], v[104:107], v[152:155]
    s_mov_b64 exec, 0xffff
    s_nop 5
    v_or_b32 v148, 1, v148
    v_mov_b32 v150, v152
    v_mov_b32 v151, v153
    global_store_dwordx4 v65, v[148:151], s[60:61] offset:2048 sc1
    s_mov_b64 exec, -1
L_NOMOE:
    s_barrier
    s_cmp_eq_u32 s3, 0
    s_cbranch_scc0 L_BAR8
    v_mov_b32 v68, s78
    v_mov_b32 v69, s79
    v_mov_b32 v70, s80
    v_mov_b32 v71, s81
    v_mov_b32 v3, 151904
    ds_write_b128 v3, v[68:71]
    s_cmp_eq_u32 s2, 255
    s_cbranch_scc0 L_26
    s_mov_b64 exec, 1
    global_store_dwordx2 v12, v[32:33], s[46:47] sc1
    s_mov_b64 exec, -1
L_26:
    s_cmp_ge_u32 s5, 27
    s_cbranch_scc1 L_BAR8
    ds_read_b64_tr_b16 v[108:109], v56 offset:0
    ds_read_b64_tr_b16 v[110:111], v56 offset:640
    ds_read_b64_tr_b16 v[112:113], v56 offset:5120
    ds_read_b64_tr_b16 v[114:115], v56 offset:5760
    ds_read_b64_tr_b16 v[116:117], v56 offset:32
    ds_read_b64_tr_b16 v[118:119], v56 offset:672
    ds_read_b64_tr_b16 v[120:121], v56 offset:5152
    ds_read_b64_tr_b16 v[122:123], v56 offset:5792
    ds_read_b64_tr_b16 v[124:125], v56 offset:64
    ds_read_b64_tr_b16 v[126:127], v56 offset:704
    ds_read_b64_tr_b16 v[128:129], v56 offset:5184
    ds_read_b64_tr_b16 v[130:131], v56 offset:5824
    s_waitcnt lgkmcnt(0)
    ds_read_b64_tr_b16 v[132:133], v56 offset:96
    ds_read_b64_tr_b16 v[134:135], v56 offset:736
    ds_read_b64_tr_b16 v[136:137], v56 offset:5216
    ds_read_b64_tr_b16 v[138:139], v56 offset:5856
    ds_read_b64_tr_b16 v[140:141], v56 offset:128
    ds_read_b64_tr_b16 v[142:143], v56 offset:768
    ds_read_b64_tr_b16 v[144:145], v56 offset:5248
    ds_read_b64_tr_b16 v[146:147], v56 offset:5888
    s_mov_b32 s74, 0xbfb8aa3b
    s_mov_b32 s14, 0
POLL_27:
    global_load_dwordx4 v[156:159], v2, s[64:65] sc1
    global_load_dwordx4 v[160:163], v2, s[64:65] offset:3072 sc1
    global_load_dwordx4 v[164:167], v80, s[64:65] sc1
    global_load_dwordx4 v[168:171], v80, s[64:65] offset:3072 sc1
    global_load_dwordx4 v[172:175], v81, s[64:65] sc1
    global_load_dwordx4 v[176:179], v81, s[64:65] offset:3072 sc1
    global_load_dwordx4 v[180:183], v82, s[64:65] sc1
    global_load_dwordx4 v[184:187], v82, s[64:65] offset:3072 sc1
    s_waitcnt vmcnt(0)
    v_and_b32 v3, v156, v160
    v_bitop3_b32 v3, v3, v164, v168 bitop3:0x80
    v_bitop3_b32 v3, v3, v172, v176 bitop3:0x80
    v_bitop3_b32 v3, v3, v180, v184 bitop3:0x80
    v_and_b32 v3, 1, v3
    v_cmp_eq_u32 vcc, 1, v3
    s_cmp_eq_u64 vcc, -1
    s_cbranch_scc1 POLLD_28
    s_add_u32 s14, s14, 1
    s_cmp_lt_u32 s14, 65536
    s_cbranch_scc1 POLL_27
POLLD_28:
    v_pk_add_f32 v[156:157], v[156:157], v[160:161]
    v_pk_add_f32 v[158:159], v[158:159], v[162:163]
    v_pk_add_f32 v[164:165], v[164:165], v[168:169]
    v_pk_add_f32 v[166:167], v[166:167], v[170:171]
    v_pk_add_f32 v[172:173], v[172:173], v[176:177]
    v_pk_add_f32 v[174:175], v[174:175], v[178:179]
    v_pk_add_f32 v[180:181], v[180:181], v[184:185]
    v_pk_add_f32 v[182:183], v[182:183], v[186:187]
    v_pk_add_f32 v[156:157], v[156:157], v[164:165]
    v_pk_add_f32 v[158:159], v[158:159], v[166:167]
    v_pk_add_f32 v[172:173], v[172:173], v[180:181]
    v_pk_add_f32 v[174:175], v[174:175], v[182:183]
    v_pk_add_f32 v[156:157], v[156:157], v[172:173]
    v_pk_add_f32 v[158:159], v[158:159], v[174:175]
    v_mul_f32 v68, s74, v156
    v_mul_f32 v69, s74, v157
    v_exp_f32 v68, v68
    v_exp_f32 v69, v69
    v_pk_mul_f32 v[156:157], v[156:157], v[158:159]
    v_add_f32 v68, 1.0, v68
    v_add_f32 v69, 1.0, v69
    v_rcp_f32 v68, v68
    v_rcp_f32 v69, v69
    s_nop 0
    v_pk_mul_f32 v[156:157], v[156:157], v[68:69]
    v_cvt_pk_bf16_f32 v68, v156, v157
    ds_write_b16 v66, v68
    ds_write_b16_d16_hi v66, v68 offset:128
    ds_read_b128 v[72:75], v67
    ds_read_b128 v[76:79], v67 offset:64
    s_waitcnt lgkmcnt(1)
    v_mfma_f32_16x16x32_bf16 v[84:87], v[72:75], v[108:111], 0
    v_mfma_f32_16x16x32_bf16 v[88:91], v[72:75], v[116:119], 0
    v_mfma_f32_16x16x32_bf16 v[92:95], v[72:75], v[124:127], 0
    v_mfma_f32_16x16x32_bf16 v[96:99], v[72:75], v[132:135], 0
    v_mfma_f32_16x16x32_bf16 v[100:103], v[72:75], v[140:143], 0
    s_waitcnt lgkmcnt(0)
    v_mfma_f32_16x16x32_bf16 v[84:87], v[76:79], v[112:115], v[84:87]
    v_mfma_f32_16x16x32_bf16 v[88:91], v[76:79], v[120:123], v[88:91]
    v_mfma_f32_16x16x32_bf16 v[92:95], v[76:79], v[128:131], v[92:95]
    v_mfma_f32_16x16x32_bf16 v[96:99], v[76:79], v[136:139], v[96:99]
    v_mfma_f32_16x16x32_bf16 v[100:103], v[76:79], v[144:147], v[100:103]
    s_mov_b64 exec, 0xffff
    s_nop 2
    s_cmp_eq_u32 s12, 1
    s_cbranch_scc0 SLOWST_29
    v_or_b32 v84, 1, v84
    v_or_b32 v85, 1, v85
    global_store_dword v7, v84, s[66:67] offset:384
    global_store_dword v7, v85, s[66:67] offset:704
    v_or_b32 v88, 1, v88
    v_or_b32 v89, 1, v89
    global_store_dword v7, v88, s[66:67] offset:448
    global_store_dword v7, v89, s[66:67] offset:768
    v_or_b32 v92, 1, v92
    v_or_b32 v93, 1, v93
    global_store_dword v7, v92, s[66:67] offset:512
    global_store_dword v7, v93, s[66:67] offset:832
    v_or_b32 v96, 1, v96
    v_or_b32 v97, 1, v97
    global_store_dword v7, v96, s[66:67] offset:576
    global_store_dword v7, v97, s[66:67] offset:896
    v_or_b32 v100, 1, v100
    v_or_b32 v101, 1, v101
    global_store_dword v7, v100, s[66:67] offset:640
    global_store_dword v7, v101, s[66:67] offset:960
STD_30:
    s_mov_b64 exec, -1
L_BAR8:
    s_mov_b32 s60, s20
    s_mov_b32 s61, s21
    s_waitcnt lgkmcnt(0)
    s_barrier
L_FIX:
    s_cmp_ge_u32 s3, 5
    s_cbranch_scc1 L_FIN
    v_mov_b32 v3, 151904
    ds_read_b128 v[12:15], v3
    v_and_b32 v16, 15, v1
    s_lshl_b32 s74, s3, 4
    v_add_u32 v16, s74, v16
    v_lshlrev_b32 v17, 2, v16
    v_add_u32 v18, 152576, v17
    ds_read_b32 v19, v18
    v_lshrrev_b32 v20, 4, v1
    v_lshlrev_b32 v21, 10, v20
    v_add_u32 v21, v21, v17
    v_cmp_eq_u32 s[72:73], 3, v20
    s_waitcnt lgkmcnt(0)
    v_readfirstlane_b32 s80, v14
    v_readfirstlane_b32 s81, v15
    v_readfirstlane_b32 s78, v12
    v_readfirstlane_b32 s79, v13
    s_lshr_b32 s74, s80, 1
    s_cmp_eq_u32 s74, s5
    s_cbranch_scc0 L_31
    v_add_u32 v24, 384, v21
    v_add_u32 v25, 4096, v24
    v_add_u32 v26, 8192, v24
    v_add_u32 v27, 12288, v24
    v_add_u32 v28, 16384, v24
    v_add_u32 v29, 20480, v24
    v_add_u32 v30, 24576, v24
    v_cndmask_b32 v30, v30, v29, s[72:73]
    global_load_dword v32, v24, s[60:61] sc1
    global_load_dword v33, v25, s[60:61] sc1
    global_load_dword v34, v26, s[60:61] sc1
    global_load_dword v35, v27, s[60:61] sc1
    global_load_dword v36, v28, s[60:61] sc1
    global_load_dword v37, v29, s[60:61] sc1
    global_load_dword v38, v30, s[60:61] sc1
    s_and_b32 s74, s80, 1
    s_mul_i32 s74, s74, 320
    s_add_u32 s74, s74, 151936
    v_add_u32 v18, s74, v17
    ds_read_b32 v22, v18
    s_and_b32 s75, s78, 0xfffff000
    s_xor_b32 s76, s75, 0x80000000
    s_not_b32 s77, s75
    s_bitcmp1_b32 s75, 31
    s_cselect_b32 s75, s76, s77
    v_mov_b32 v23, s75
    v_mul_f32 v23, 0xbfb8aa3b, v23
    v_exp_f32 v23, v23
    s_and_b32 s75, s78, 0x7ff
    v_add_f32 v23, 1.0, v23
    v_rcp_f32 v23, v23
    s_sub_u32 s75, 2047, s75
    v_mul_f32 v23, v23, v19
    s_mul_i32 s75, s75, 1280
    s_mul_i32 s76, s4, 160
    s_add_u32 s75, s75, s76
    v_lshlrev_b32 v40, 1, v16
    v_add_u32 v40, s75, v40
    s_mov_b32 s14, 0
L_32:
    s_waitcnt vmcnt(0)
    v_bitop3_b32 v39, v32, v33, v34 bitop3:0x80
    v_bitop3_b32 v39, v39, v35, v36 bitop3:0x80
    v_bitop3_b32 v39, v39, v37, v38 bitop3:0x80
    v_and_b32 v39, 1, v39
    v_cmp_eq_u32 vcc, 1, v39
    s_cmp_eq_u64 vcc, -1
    s_cbranch_scc1 L_33
    global_load_dword v32, v24, s[60:61] sc1
    global_load_dword v33, v25, s[60:61] sc1
    global_load_dword v34, v26, s[60:61] sc1
    global_load_dword v35, v27, s[60:61] sc1
    global_load_dword v36, v28, s[60:61] sc1
    global_load_dword v37, v29, s[60:61] sc1
    global_load_dword v38, v30, s[60:61] sc1
    s_add_u32 s14, s14, 1
    s_cmp_lt_u32 s14, 65536
    s_cbranch_scc1 L_32
    s_waitcnt vmcnt(0)
L_33:
    v_cndmask_b32 v38, v38, 0, s[72:73]
    v_add_f32 v32, v32, v33
    v_add_f32 v34, v34, v35
    v_add_f32 v36, v36, v37
    v_add_f32 v32, v32, v34
    v_add_f32 v36, v36, v38
    v_add_f32 v32, v32, v36
    v_mov_b32 v33, v32
    s_nop 1
    v_permlane32_swap_b32 v32, v33
    v_add_f32 v32, v32, v33
    v_mov_b32 v33, v32
    s_nop 1
    v_permlane16_swap_b32 v32, v33
    v_add_f32 v32, v32, v33
    s_waitcnt lgkmcnt(0)
    v_fma_f32 v32, v32, v23, v22
    v_cvt_pk_bf16_f32 v32, v32, v32
    s_mov_b64 exec, 0xffff
    global_store_short v40, v32, s[42:43]
    s_mov_b64 exec, -1
L_31:
    s_lshr_b32 s74, s81, 1
    s_cmp_eq_u32 s74, s5
    s_cbranch_scc0 L_34
    v_add_u32 v24, 704, v21
    v_add_u32 v25, 4096, v24
    v_add_u32 v26, 8192, v24
    v_add_u32 v27, 12288, v24
    v_add_u32 v28, 16384, v24
    v_add_u32 v29, 20480, v24
    v_add_u32 v30, 24576, v24
    v_cndmask_b32 v30, v30, v29, s[72:73]
    global_load_dword v32, v24, s[60:61] sc1
    global_load_dword v33, v25, s[60:61] sc1
    global_load_dword v34, v26, s[60:61] sc1
    global_load_dword v35, v27, s[60:61] sc1
    global_load_dword v36, v28, s[60:61] sc1
    global_load_dword v37, v29, s[60:61] sc1
    global_load_dword v38, v30, s[60:61] sc1
    s_and_b32 s74, s81, 1
    s_mul_i32 s74, s74, 320
    s_add_u32 s74, s74, 151936
    v_add_u32 v18, s74, v17
    ds_read_b32 v22, v18
    s_and_b32 s75, s79, 0xfffff000
    s_xor_b32 s76, s75, 0x80000000
    s_not_b32 s77, s75
    s_bitcmp1_b32 s75, 31
    s_cselect_b32 s75, s76, s77
    v_mov_b32 v23, s75
    v_mul_f32 v23, 0xbfb8aa3b, v23
    v_exp_f32 v23, v23
    s_and_b32 s75, s79, 0x7ff
    v_add_f32 v23, 1.0, v23
    v_rcp_f32 v23, v23
    s_sub_u32 s75, 2047, s75
    v_mul_f32 v23, v23, v19
    s_mul_i32 s75, s75, 1280
    s_mul_i32 s76, s4, 160
    s_add_u32 s75, s75, s76
    v_lshlrev_b32 v40, 1, v16
    v_add_u32 v40, s75, v40
    s_mov_b32 s14, 0
L_35:
    s_waitcnt vmcnt(0)
    v_bitop3_b32 v39, v32, v33, v34 bitop3:0x80
    v_bitop3_b32 v39, v39, v35, v36 bitop3:0x80
    v_bitop3_b32 v39, v39, v37, v38 bitop3:0x80
    v_and_b32 v39, 1, v39
    v_cmp_eq_u32 vcc, 1, v39
    s_cmp_eq_u64 vcc, -1
    s_cbranch_scc1 L_36
    global_load_dword v32, v24, s[60:61] sc1
    global_load_dword v33, v25, s[60:61] sc1
    global_load_dword v34, v26, s[60:61] sc1
    global_load_dword v35, v27, s[60:61] sc1
    global_load_dword v36, v28, s[60:61] sc1
    global_load_dword v37, v29, s[60:61] sc1
    global_load_dword v38, v30, s[60:61] sc1
    s_add_u32 s14, s14, 1
    s_cmp_lt_u32 s14, 65536
    s_cbranch_scc1 L_35
    s_waitcnt vmcnt(0)
L_36:
    v_cndmask_b32 v38, v38, 0, s[72:73]
    v_add_f32 v32, v32, v33
    v_add_f32 v34, v34, v35
    v_add_f32 v36, v36, v37
    v_add_f32 v32, v32, v34
    v_add_f32 v36, v36, v38
    v_add_f32 v32, v32, v36
    v_mov_b32 v33, v32
    s_nop 1
    v_permlane32_swap_b32 v32, v33
    v_add_f32 v32, v32, v33
    v_mov_b32 v33, v32
    s_nop 1
    v_permlane16_swap_b32 v32, v33
    v_add_f32 v32, v32, v33
    s_waitcnt lgkmcnt(0)
    v_fma_f32 v32, v32, v23, v22
    v_cvt_pk_bf16_f32 v32, v32, v32
    s_mov_b64 exec, 0xffff
    global_store_short v40, v32, s[42:43]
    s_mov_b64 exec, -1
L_34:
L_FIN:
    s_endpgm
L_HELPER:
    s_cmp_ge_u32 s3, 6
    s_cbranch_scc1 L_37
    s_add_u32 s75, s75, 4096
    s_mov_b32 m0, s75
    s_nop 0
    global_load_lds_dwordx4 v35, s[20:21]
L_37:
    s_mul_i32 s76, s81, 1228800
    s_lshl_b32 s77, s8, 7
    s_add_u32 s76, s76, s77
    s_mul_i32 s77, s15, 61440
    s_add_u32 s76, s76, s77
    s_add_u32 s28, s40, s76
    s_addc_u32 s29, s41, 0
    s_mul_i32 s76, s81, 30720
    s_lshl_b32 s77, s8, 9
    s_add_u32 s76, s76, s77
    s_lshl_b32 s77, s15, 7
    s_add_u32 s76, s76, s77
    s_add_u32 s76, s76, 1310720
    s_add_u32 s40, s46, s76
    s_addc_u32 s41, s47, 0
    s_and_b32 s74, s54, -2
    s_lshl_b32 s74, s74, 1
    s_load_dword s78, s[26:27], s74
    s_cmp_eq_u32 s53, 1
    s_mov_b32 s76, 2048
    s_cmov_b32 s76, 4096
    v_add_u32 v68, s76, v2
    s_barrier
    v_and_b32 v4, 255, v0
    v_mul_u32_u24 v6, 6554, v4
    v_lshrrev_b32 v6, 16, v6
    v_mul_u32_u24 v6, 1120, v6
    v_lshl_add_u32 v8, v4, 4, v6
    v_add_u32 v4, 256, v4
    v_mul_u32_u24 v6, 6554, v4
    v_lshrrev_b32 v6, 16, v6
    v_mul_u32_u24 v6, 1120, v6
    v_lshl_add_u32 v9, v4, 4, v6
    s_add_u32 s74, s15, 8
    s_cmp_lt_u32 s15, 2
    s_cselect_b32 s0, s74, s15
    s_cselect_b64 vcc, -1, 0
    s_lshl_b32 s8, s0, 10
    v_cndmask_b32 v10, v8, v10, vcc
    v_add_u32 v8, s52, v8
    v_add_u32 v9, s52, v9
    v_add_u32 v10, s52, v10
    s_getreg_b32 s13, hwreg(HW_REG_XCC_ID)
    s_cmp_eq_u32 s53, 1
    s_mov_b32 s56, 4768
    s_cmov_b32 s56, 2720
    s_mov_b32 s57, 9536
    s_cmov_b32 s57, 5440
    s_mov_b32 s58, 4224
    s_cmov_b32 s58, 2176
    s_mov_b32 s59, 17984
    s_cmov_b32 s59, 9792
    s_lshl_b32 s77, s15, s53
    s_mul_i32 s55, s77, s59
    s_and_b32 s13, s13, 15
    s_lshl_b32 s74, s4, 5
    s_add_u32 s74, s74, s5
    s_lshl_b32 s74, s74, 10
    s_add_u32 s74, s74, 32768
    s_add_u32 s66, s46, s74
    s_addc_u32 s67, s47, 0
    s_mul_i32 s74, s5, 24576
    s_add_u32 s74, s74, 458752
    s_add_u32 s68, s46, s74
    s_addc_u32 s69, s47, 0
    s_lshl_b32 s74, s4, 12
    s_add_u32 s74, s74, 425984
    s_add_u32 s70, s46, s74
    s_addc_u32 s71, s47, 0
    s_lshl_b32 s7, s15, 10
    v_mov_b32 v152, 0
    v_mov_b32 v153, 0
    v_mov_b32 v154, 0
    v_mov_b32 v155, 0
    s_lshr_b32 s74, 4096, s53
    s_add_u32 s74, s74, s55
    v_add_u32 v4, s74, v2
    v_add_u32 v5, s56, v4
    s_add_u32 s75, s55, s57
    s_add_u32 s75, s75, s58
    v_and_b32 v6, 0x30, v2
    v_add_u32 v6, s75, v6
    ds_write_b128 v4, v[152:155] offset:0
    ds_write_b128 v5, v[152:155] offset:0
    ds_write_b128 v6, v[152:155] offset:0
    s_cmp_eq_u32 s53, 1
    s_cbranch_scc0 L_38
    ds_write_b128 v4, v[152:155] offset:9792
    ds_write_b128 v5, v[152:155] offset:9792
    ds_write_b128 v6, v[152:155] offset:9792
L_38:
    v_mov_b32 v4, 151872
    ds_write_b128 v4, v[152:155]
    ds_write_b128 v4, v[152:155] offset:16
    s_mul_i32 s74, s15, 80
    s_add_u32 s74, s74, 151552
    v_add_u32 v36, s74, v36
    v_lshrrev_b32 v4, 4, v1
    v_bfe_u32 v5, v1, 2, 2
    v_lshl_add_u32 v5, v4, 3, v5
    v_lshlrev_b32 v5, 7, v5
    v_and_b32 v6, 3, v1
    v_lshl_add_u32 v5, v6, 3, v5
    s_lshl_b32 s74, s15, 5
    s_add_u32 s74, s74, 99840
    v_add_u32 v113, s74, v5
    v_lshlrev_b32 v4, 4, v4
    v_add_u32 v114, 151552, v4
    v_lshrrev_b32 v6, 3, v1
    v_and_b32 v7, 0x70, v2
    s_min_u32 s76, s5, 26
    v_mul_u32_u24 v6, 3456, v6
    v_add_u32 v6, v6, v7
    s_mul_i32 s74, s4, 276480
    s_lshl_b32 s75, s76, 7
    s_add_u32 s77, s74, s75
    s_mul_i32 s74, s15, 27648
    s_add_u32 s74, s74, s77
    v_add_u32 v109, s74, v6
    v_add_u32 v110, 110592, v109
    s_mul_i32 s74, s0, 27648
    s_add_u32 s74, s74, s77
    v_add_u32 v111, s74, v6
    v_lshrrev_b32 v136, 3, v1
    v_mul_u32_u24 v136, 7680, v136
    v_and_b32 v4, 0x70, v2
    v_add_u32 v136, v136, v4
    s_lshl_b32 s74, s4, 11
    s_add_u32 s74, s74, 4096
    s_add_u32 s64, s46, s74
    s_addc_u32 s65, s47, 0
    v_and_b32 v67, 31, v1
    v_lshlrev_b32 v67, 6, v67
    s_mul_i32 s74, s4, 80
    s_mul_i32 s75, s15, 20
    s_add_u32 s74, s74, s75
    v_min_u32 v137, 19, v1
    v_add_u32 v137, s74, v137
    v_lshlrev_b32 v137, 1, v137
    v_lshrrev_b32 v4, 4, v1
    v_lshlrev_b32 v5, 10, v4
    v_and_b32 v6, 0xf0, v2
    s_lshl_b32 s74, s15, 8
    v_add_u32 v141, s74, v6
    v_add_u32 v139, v141, v5
    v_mul_u32_u24 v6, 10, v6
    v_lshl_add_u32 v6, v4, 4, v6
    s_mul_i32 s81, s15, 2560
    s_add_u32 s81, s81, 130560
    v_add_u32 v140, s81, v6
    s_cmp_lt_u32 s3, 6
    s_cbranch_scc1 L_39
    s_waitcnt vmcnt(6)
L_39:
    s_waitcnt vmcnt(7)
    v_lshlrev_b32 v116, 16, v116
    v_mul_f32 v117, 0xbfb8aa3b, v116
    v_exp_f32 v117, v117
    s_nop 0
    v_add_f32 v117, 1.0, v117
    v_rcp_f32 v117, v117
    s_nop 0
    v_mul_f32 v116, v116, v117
    v_cvt_pk_bf16_f32 v116, v116, v116
    ds_write_b16 v36, v116
    s_waitcnt lgkmcnt(0)
    s_mul_i32 s10, s10, 0x9E3779B1
    s_add_u32 s10, s10, 0x7F4A7C15
    s_or_b32 s10, s10, 1
    s_mul_i32 s11, s11, 0x85EBCA6B
    s_add_u32 s11, s11, 0xC2B2AE35
    s_lshl_b32 s74, s4, 5
    s_add_u32 s74, s74, s5
    s_mul_i32 s74, s74, 10240
    s_mul_i32 s75, s15, 2560
    s_add_u32 s74, s74, s75
    s_add_u32 s74, s74, 2097152
    s_add_u32 s18, s46, s74
    s_addc_u32 s19, s47, 0
    v_min_u32 v69, 19, v1
    v_lshlrev_b32 v69, 7, v69
    global_load_dword v105, v69, s[18:19] sc1
    s_waitcnt vmcnt(1)
    s_barrier
    global_load_dwordx2 v[106:107], v67, s[64:65] sc1
    global_load_ushort v61, v137, s[30:31]
    s_add_u32 s74, s7, 130560
    s_mov_b32 m0, s74
    s_add_u32 s74, s74, 4096
    global_load_lds_dwordx4 v8, s[16:17]
    s_mov_b32 m0, s74
    s_add_u32 s74, s8, 130560
    global_load_lds_dwordx4 v9, s[16:17]
    s_mov_b32 m0, s74
    s_nop 0
    global_load_lds_dwordx4 v10, s[16:17]
    s_add_u32 s74, s7, 99840
    s_mov_b32 m0, s74
    s_add_u32 s74, s74, 4096
    global_load_lds_dwordx4 v136, s[28:29]
    s_add_u32 s28, s28, 0x3c000
    s_addc_u32 s29, s29, 0
    s_mov_b32 m0, s74
    s_add_u32 s74, s74, 4096
    global_load_lds_dwordx4 v136, s[28:29]
    s_add_u32 s28, s28, 0x3c000
    s_addc_u32 s29, s29, 0
    s_mov_b32 m0, s74
    s_add_u32 s74, s74, 4096
    global_load_lds_dwordx4 v136, s[28:29]
    s_add_u32 s28, s28, 0x3c000
    s_addc_u32 s29, s29, 0
    s_mov_b32 m0, s74
    s_add_u32 s74, s74, 4096
    global_load_lds_dwordx4 v136, s[28:29]
    s_add_u32 s28, s28, 0x3c000
    s_addc_u32 s29, s29, 0
    s_mov_b32 m0, s74
    s_add_u32 s74, s74, 4096
    global_load_lds_dwordx4 v136, s[28:29]
    s_lshr_b32 s74, 4096, s53
    s_add_u32 s74, s74, s55
    s_sub_u32 s74, s74, 16
    v_sub_u32 v62, s74, v2
    v_subrev_u32 v63, 1024, v62
    s_cmp_eq_u32 s53, 1
    s_mov_b32 s74, 4294965248
    s_cmov_b32 s74, 9792
    v_add_u32 v64, s74, v62
    v_add_u32 v65, s74, v63
    s_mul_i32 s74, s4, 32768
    s_add_u32 s74, s74, 32768
    s_add_u32 s60, s46, s74
    s_addc_u32 s61, s47, 0
    s_mul_i32 s74, s4, 640
    s_mul_i32 s75, s15, 160
    s_add_u32 s74, s74, s75
    s_add_u32 s74, s74, 1310720
    s_add_u32 s22, s46, s74
    s_addc_u32 s23, s47, 0
    s_mul_i32 s74, s4, 3072
    s_add_u32 s62, s68, s74
    s_addc_u32 s63, s69, 0
    s_mul_i32 s74, s4, 327680
    s_add_u32 s74, s74, 5242880
    s_add_u32 s26, s46, s74
    s_addc_u32 s27, s47, 0
    s_lshl_b32 s74, s5, 2
    s_add_u32 s74, s74, s15
    s_mul_i32 s74, s74, 10
    v_min_u32 v115, 9, v1
    v_add_u32 v115, s74, v115
    v_lshrrev_b32 v4, 4, v115
    v_and_b32 v115, 15, v115
    v_lshlrev_b32 v115, 7, v115
    v_lshl_add_u32 v115, v4, 12, v115
    s_cmp_eq_u32 s15, 0
    s_cbranch_scc0 L_40
    s_waitcnt vmcnt(9)
    s_mov_b32 s14, 0
POLL_41:
    v_subrev_u32 v4, s11, v107
    v_cmp_eq_u32 s[72:73], s10, v106
    v_cmp_eq_u32 vcc, s13, v4
    s_and_b64 vcc, vcc, s[72:73]
    s_mov_b32 s12, 1
    s_cmp_eq_u64 vcc, -1
    s_cbranch_scc1 L_42
    s_mov_b32 s12, 2
    v_cmp_gt_u32 vcc, 16, v4
    s_and_b64 vcc, vcc, s[72:73]
    s_cmp_eq_u64 vcc, -1
    s_cbranch_scc1 L_42
    global_load_dwordx2 v[106:107], v67, s[64:65] sc1
    s_add_u32 s14, s14, 1
    s_waitcnt vmcnt(0)
    s_cmp_lt_u32 s14, 65536
    s_cbranch_scc1 POLL_41
L_42:
    v_mov_b32 v4, s12
    v_mov_b32 v5, 151892
    ds_write_b32 v5, v4
L_40:
    s_add_u32 s64, s68, 0x400
    s_addc_u32 s65, s69, 0
    v_mul_u32_u24 v148, 160, v1
    s_mul_i32 s74, s15, 40
    v_add_u32 v148, s74, v148
    v_add_u32 v149, 6144, v2
    v_add_u32 v150, 12288, v2
    v_add_u32 v151, 18432, v2
    s_mov_b32 s74, 0xffff
    s_lshl_b32 s76, s78, 16
    s_and_b32 s77, s78, 0xffff0000
    s_bitcmp1_b32 s54, 0
    s_cselect_b32 s76, s77, s76
    s_mov_b64 exec, 1
    v_lshlrev_b32 v4, 16, v12
    v_add_f32 v4, s76, v4
    v_cvt_pk_bf16_f32 v4, v4, v4
    v_bfi_b32 v12, s74, v4, v12
    s_mov_b64 exec, -1
L_43:
    v_mov_b32 v3, 0
    v_alignbit_b32 v68, v15, v15, 16
    v_alignbit_b32 v69, v14, v14, 16
    v_mov_b32_dpp v3, v15 wave_shr:1 row_mask:0xf bank_mask:0xf
    v_alignbit_b32 v70, v13, v13, 16
    v_alignbit_b32 v71, v12, v12, 16
    v_add_u32 v4, s56, v62
    v_bfi_b32 v72, s74, v15, v14
    ds_write_b128 v4, v[68:71]
    v_bfi_b32 v73, s74, v14, v13
    v_bfi_b32 v74, s74, v13, v12
    v_bfi_b32 v75, s74, v12, v3
    ds_write_b128 v62, v[72:75]
    v_readlane_b32 s75, v15, 63
    s_nop 1
    v_mov_b32 v3, s75
    v_alignbit_b32 v76, v19, v19, 16
    v_alignbit_b32 v77, v18, v18, 16
    v_mov_b32_dpp v3, v19 wave_shr:1 row_mask:0xf bank_mask:0xf
    v_alignbit_b32 v78, v17, v17, 16
    v_alignbit_b32 v79, v16, v16, 16
    v_add_u32 v4, s56, v63
    v_bfi_b32 v80, s74, v19, v18
    ds_write_b128 v4, v[76:79]
    v_bfi_b32 v81, s74, v18, v17
    v_bfi_b32 v82, s74, v17, v16
    v_bfi_b32 v83, s74, v16, v3
    ds_write_b128 v63, v[80:83]
    s_cmp_eq_u32 s53, 1
    s_cbranch_scc0 L_44
    s_and_b32 s76, s78, 0xffff0000
    s_mov_b64 exec, 1
    v_lshlrev_b32 v4, 16, v20
    v_add_f32 v4, s76, v4
    v_cvt_pk_bf16_f32 v4, v4, v4
    v_bfi_b32 v20, s74, v4, v20
    s_mov_b64 exec, -1
L_44:
    v_readlane_b32 s75, v19, 63
    s_cmp_eq_u32 s53, 1
    s_cselect_b32 s75, 0, s75
    v_mov_b32 v3, s75
    v_alignbit_b32 v84, v23, v23, 16
    v_alignbit_b32 v85, v22, v22, 16
    v_mov_b32_dpp v3, v23 wave_shr:1 row_mask:0xf bank_mask:0xf
    v_alignbit_b32 v86, v21, v21, 16
    v_alignbit_b32 v87, v20, v20, 16
    v_add_u32 v4, s56, v64
    v_bfi_b32 v88, s74, v23, v22
    ds_write_b128 v4, v[84:87]
    v_bfi_b32 v89, s74, v22, v21
    v_bfi_b32 v90, s74, v21, v20
    v_bfi_b32 v91, s74, v20, v3
    ds_write_b128 v64, v[88:91]
    v_readlane_b32 s75, v23, 63
    s_nop 1
    v_mov_b32 v3, s75
    v_alignbit_b32 v92, v27, v27, 16
    v_alignbit_b32 v93, v26, v26, 16
    v_mov_b32_dpp v3, v27 wave_shr:1 row_mask:0xf bank_mask:0xf
    v_alignbit_b32 v94, v25, v25, 16
    v_alignbit_b32 v95, v24, v24, 16
    v_add_u32 v4, s56, v65
    v_bfi_b32 v96, s74, v27, v26
    ds_write_b128 v4, v[92:95]
    v_bfi_b32 v97, s74, v26, v25
    v_bfi_b32 v98, s74, v25, v24
    v_bfi_b32 v99, s74, v24, v3
    ds_write_b128 v65, v[96:99]
    s_waitcnt vmcnt(8)
    v_lshlrev_b32 v61, 16, v61
    v_and_b32 v3, 0x70, v2
    v_add_u32 v3, 88576, v3
    v_mov_b32 v4, 151892
    ds_read_b128 v[116:119], v114 offset:0
    ds_read_b128 v[120:123], v114 offset:64
    ds_read_b128 v[124:127], v114 offset:128
    ds_read_b128 v[128:131], v114 offset:192
    ds_read_b128 v[132:135], v114 offset:256
    v_mov_b32 v50, s10
    v_mov_b32 v51, s11
    v_lshlrev_b32 v52, 3, v1
    s_mov_b32 s74, 0x3f803f80
    v_mov_b32 v172, s74
    v_mov_b32 v173, s74
    v_mov_b32 v174, s74
    v_mov_b32 v175, s74
    v_and_b32 v5, 3, v1
    v_cmp_eq_u32 s[78:79], 1, v5
    v_cmp_eq_u32 s[80:81], 2, v5
    v_cmp_eq_u32 s[72:73], 3, v5
    v_cmp_gt_u32 vcc, 32, v1
    v_add_u32 v142, 130560, v148
    s_lshl_b32 s74, s5, 4
    s_lshl_b32 s75, s15, 3
    s_add_u32 s74, s74, s75
    v_mov_b32 v143, s74
    s_waitcnt vmcnt(0) lgkmcnt(0)
    s_barrier
    ds_read_b64_tr_b16 v[28:29], v113 offset:0
    ds_read_b64_tr_b16 v[30:31], v113 offset:512
    ds_read_b64_tr_b16 v[32:33], v113 offset:4096
    ds_read_b64_tr_b16 v[34:35], v113 offset:4608
    ds_read_b64_tr_b16 v[36:37], v113 offset:8192
    ds_read_b64_tr_b16 v[38:39], v113 offset:8704
    ds_read_b64_tr_b16 v[40:41], v113 offset:12288
    ds_read_b64_tr_b16 v[42:43], v113 offset:12800
    ds_read_b64_tr_b16 v[44:45], v113 offset:16384
    ds_read_b64_tr_b16 v[46:47], v113 offset:16896
    ds_read_b128 v[160:163], v140 offset:0
    ds_read_b128 v[164:167], v140 offset:64
    ds_read_b128 v[168:171], v140 offset:128
    s_waitcnt lgkmcnt(11)
    v_mfma_f32_16x16x32_bf16 v[56:59], v[116:119], v[28:31], 0
    s_waitcnt lgkmcnt(9)
    v_mfma_f32_16x16x32_bf16 v[56:59], v[120:123], v[32:35], v[56:59]
    s_waitcnt lgkmcnt(7)
    v_mfma_f32_16x16x32_bf16 v[56:59], v[124:127], v[36:39], v[56:59]
    s_waitcnt lgkmcnt(5)
    v_mfma_f32_16x16x32_bf16 v[56:59], v[128:131], v[40:43], v[56:59]
    s_waitcnt lgkmcnt(3)
    v_mfma_f32_16x16x32_bf16 v[56:59], v[132:135], v[44:47], v[56:59]
    s_waitcnt lgkmcnt(0)
    ds_read_b64 v[66:67], v142 offset:0
    ds_read_b64 v[68:69], v142 offset:8
    ds_read_b64 v[70:71], v142 offset:16
    ds_read_b64 v[72:73], v142 offset:24
    ds_read_b64 v[74:75], v142 offset:32
    ds_read_b32 v6, v4
    v_cndmask_b32 v168, 0, v168, vcc
    v_cndmask_b32 v169, 0, v169, vcc
    v_cndmask_b32 v170, 0, v170, vcc
    v_cndmask_b32 v171, 0, v171, vcc
    v_mfma_f32_16x16x32_bf16 v[176:179], v[160:163], v[172:175], 0
    v_mfma_f32_16x16x32_bf16 v[180:183], v[160:163], v[160:163], 0
    v_mfma_f32_16x16x32_bf16 v[176:179], v[164:167], v[172:175], v[176:179]
    v_mfma_f32_16x16x32_bf16 v[180:183], v[164:167], v[164:167], v[180:183]
    v_mfma_f32_16x16x32_bf16 v[176:179], v[168:171], v[172:175], v[176:179]
    v_mfma_f32_16x16x32_bf16 v[180:183], v[168:171], v[168:171], v[180:183]
    v_mov_b32 v48, v56
    v_mov_b32_dpp v49, v56 quad_perm:[1,1,3,3] row_mask:0xf bank_mask:0xf
    s_waitcnt lgkmcnt(0)
    s_barrier
    s_mov_b32 exec_hi, 0
    global_store_dwordx4 v139, v[152:155], s[62:63] offset:1024 sc1
    s_mov_b64 exec, -1
    s_cmp_eq_u32 s15, 1
    s_cbranch_scc1 L_45
    s_cmp_ge_u32 s15, 2
    s_cbranch_scc1 L_48
    global_store_dwordx4 v2, v[152:155], s[66:67] sc1
    s_branch L_48
L_45:
    s_cmp_eq_u32 s5, 0
    s_cbranch_scc0 L_48
    s_mov_b64 exec, 0xffff
    global_store_dwordx4 v2, v[152:155], s[70:71] offset:2048 sc1
    s_mov_b64 exec, -1
L_48:
    s_cmp_ge_u32 s2, 240
    s_cselect_b32 exec_lo, 0, 0x5555
    s_mov_b32 exec_hi, 0
    s_cbranch_scc1 L_49
    global_store_dwordx4 v52, v[48:51], s[40:41] sc1
    s_branch L_49x
L_49:
    s_mov_b64 exec, -1
    global_load_dword v106, v2, s[70:71] sc1
L_49x:
    s_mov_b64 exec, -1
    global_load_dword v104, v115, s[26:27] sc1
    s_add_u32 s74, s7, 78336
    s_mov_b32 m0, s74
    s_add_u32 s74, s74, 4096
    global_load_lds_dwordx4 v109, s[32:33]
    s_mov_b32 m0, s74
    s_add_u32 s74, s8, 78336
    global_load_lds_dwordx4 v110, s[32:33]
    s_mov_b32 m0, s74
    s_nop 0
    global_load_lds_dwordx4 v111, s[32:33]
    s_add_u32 s74, s7, 88704
    s_mov_b32 m0, s74
    s_add_u32 s74, s74, 4096
    global_load_lds_dwordx4 v109, s[34:35]
    s_mov_b32 m0, s74
    s_add_u32 s74, s8, 88704
    global_load_lds_dwordx4 v110, s[34:35]
    s_mov_b32 m0, s74
    s_nop 0
    global_load_lds_dwordx4 v111, s[34:35]
    v_readfirstlane_b32 s12, v6
    v_cndmask_b32 v56, v176, v177, s[78:79]
    v_cndmask_b32 v56, v56, v178, s[80:81]
    v_cndmask_b32 v56, v56, v179, s[72:73]
    v_cndmask_b32 v57, v180, v181, s[78:79]
    v_cndmask_b32 v57, v57, v182, s[80:81]
    v_cndmask_b32 v57, v57, v183, s[72:73]
    v_mov_b32 v58, v50
    v_mov_b32 v59, v51
    ds_write_b128 v3, v[152:155]
    ds_write_b128 v3, v[152:155] offset:10368
    s_waitcnt vmcnt(8)
    s_mov_b32 exec_lo, 0x00f0000f
    s_mov_b32 exec_hi, 0xf0000f00
    global_store_dwordx4 v141, v[56:59], s[62:63] sc1
    s_cmp_ge_u32 s15, 2
    s_cbranch_scc1 L_50
    s_mov_b64 exec, 1
    s_cmp_eq_u32 s12, 1
    s_cbranch_scc0 SLOWST_51
    global_store_dwordx2 v143, v[58:59], s[70:71] offset:2304
STD_52:
    s_mov_b64 exec, -1
    v_min_u32 v5, 7, v1
    v_lshlrev_b32 v5, 7, v5
    global_load_dword v105, v5, s[66:67] sc1
L_50:
    s_mov_b64 exec, -1
    v_lshlrev_b32 v7, 3, v1
    v_min_u32 v3, 59, v1
    v_mul_u32_u24 v4, 6554, v3
    v_lshrrev_b32 v4, 16, v4
    v_mul_u32_u24 v4, 4960, v4
    v_lshl_add_u32 v144, v3, 4, v4
    v_add_u32 v145, 30720, v144
    v_add_u32 v146, 61440, v144
    v_add_u32 v147, 92160, v144
    global_load_dwordx4 v[116:119], v144, s[22:23] sc1
    global_load_dwordx4 v[120:123], v145, s[22:23] sc1
    global_load_dwordx4 v[124:127], v146, s[22:23] sc1
    global_load_dwordx4 v[128:131], v147, s[22:23] sc1
    s_lshl_b32 s74, s15, 10
    s_add_u32 s74, s74, 145408
    v_lshlrev_b32 v23, 3, v3
    v_add_u32 v23, s74, v23
    v_min_u32 v26, 19, v1
    v_lshlrev_b32 v26, 2, v26
    v_add_u32 v24, s74, v26
    v_mov_b32 v25, s74
    s_mul_i32 s75, s15, 80
    s_add_u32 s75, s75, 152576
    v_add_u32 v26, s75, v26
    v_mov_b32 v19, v148
    v_mov_b32 v20, v149
    v_mov_b32 v21, v150
    v_mov_b32 v22, v151
    v_bfe_u32 v4, v1, 2, 2
    s_mul_i32 s75, s15, 2560
    s_add_u32 s75, s75, 120320
    v_lshlrev_b32 v4, 7, v4
    v_lshrrev_b32 v65, 4, v1
    v_lshl_add_u32 v4, v65, 5, v4
    v_and_b32 v65, 3, v1
    v_lshl_add_u32 v4, v65, 3, v4
    v_add_u32 v65, s75, v4
    s_lshl_b32 s75, s15, 10
    s_add_u32 s75, s75, 140800
    v_add_u32 v60, s75, v2
    v_lshlrev_b32 v76, 16, v66
    v_and_b32 v77, 0xffff0000, v66
    v_lshlrev_b32 v78, 16, v67
    v_and_b32 v79, 0xffff0000, v67
    v_lshlrev_b32 v80, 16, v68
    v_and_b32 v81, 0xffff0000, v68
    v_lshlrev_b32 v82, 16, v69
    v_and_b32 v83, 0xffff0000, v69
    v_lshlrev_b32 v84, 16, v70
    v_and_b32 v85, 0xffff0000, v70
    v_lshlrev_b32 v86, 16, v71
    v_and_b32 v87, 0xffff0000, v71
    v_lshlrev_b32 v88, 16, v72
    v_and_b32 v89, 0xffff0000, v72
    v_lshlrev_b32 v90, 16, v73
    v_and_b32 v91, 0xffff0000, v73
    v_lshlrev_b32 v92, 16, v74
    v_and_b32 v93, 0xffff0000, v74
    v_lshlrev_b32 v94, 16, v75
    v_and_b32 v95, 0xffff0000, v75
    s_mov_b32 s14, 0
L_53:
    s_waitcnt vmcnt(0)
    v_cmp_eq_u32 vcc, s10, v118
    v_cmp_eq_u32 s[72:73], s11, v119
    s_and_b64 vcc, vcc, s[72:73]
    v_cmp_eq_u32 s[72:73], s10, v122
    s_and_b64 vcc, vcc, s[72:73]
    v_cmp_eq_u32 s[72:73], s11, v123
    s_and_b64 vcc, vcc, s[72:73]
    v_cmp_eq_u32 s[72:73], s10, v126
    s_and_b64 vcc, vcc, s[72:73]
    v_cmp_eq_u32 s[72:73], s11, v127
    s_and_b64 vcc, vcc, s[72:73]
    v_cmp_eq_u32 s[72:73], s10, v130
    s_and_b64 vcc, vcc, s[72:73]
    v_cmp_eq_u32 s[72:73], s11, v131
    s_and_b64 vcc, vcc, s[72:73]
    s_cmp_eq_u64 vcc, -1
    s_cbranch_scc1 L_54
    s_sleep 2
    global_load_dwordx4 v[116:119], v144, s[22:23] sc1
    global_load_dwordx4 v[120:123], v145, s[22:23] sc1
    global_load_dwordx4 v[124:127], v146, s[22:23] sc1
    global_load_dwordx4 v[128:131], v147, s[22:23] sc1
    s_add_u32 s14, s14, 1
    s_cmp_lt_u32 s14, 65536
    s_cbranch_scc1 L_53
    s_waitcnt vmcnt(0)
L_54:
    global_load_dwordx2 v[62:63], v7, s[70:71] offset:2304 sc1
    global_load_dwordx4 v[28:31], v2, s[68:69] sc1
    global_load_dwordx4 v[32:35], v2, s[68:69] offset:3072 sc1
    global_load_dwordx4 v[36:39], v20, s[68:69] sc1
    global_load_dwordx4 v[40:43], v20, s[68:69] offset:3072 sc1
    global_load_dwordx4 v[44:47], v21, s[68:69] sc1
    global_load_dwordx4 v[48:51], v21, s[68:69] offset:3072 sc1
    global_load_dwordx4 v[52:55], v22, s[68:69] sc1
    global_load_dwordx4 v[56:59], v22, s[68:69] offset:3072 sc1
    v_add_f32 v116, v116, v120
    v_add_f32 v117, v117, v121
    v_add_f32 v124, v124, v128
    v_add_f32 v125, v125, v129
    v_add_f32 v116, v116, v124
    v_add_f32 v117, v117, v125
    v_cvt_pk_bf16_f32 v120, v116, v117
    v_lshlrev_b32 v116, 16, v120
    v_and_b32 v117, 0xffff0000, v120
    ds_write_b64 v23, v[116:117]
    ds_read_b32 v120, v24 offset:0
    ds_read_b32 v121, v24 offset:80
    ds_read_b32 v122, v24 offset:160
    ds_read_b32 v123, v24 offset:240
    ds_read_b32 v124, v24 offset:320
    ds_read_b32 v125, v24 offset:400
    v_cmp_gt_u32 vcc, 20, v1
    s_waitcnt lgkmcnt(0)
    v_add_f32 v121, 1.0, v121
    v_add_f32 v124, 1.0, v124
    v_cvt_pk_bf16_f32 v126, v121, v124
    v_mul_f32 v120, v120, v122
    v_lshlrev_b32 v121, 16, v126
    v_and_b32 v124, 0xffff0000, v126
    v_mul_f32 v121, v121, v122
    v_mul_f32 v126, v124, v61
    v_mul_f32 v127, v123, v61
    ds_write_b32 v24, v121 offset:0
    ds_write_b32 v24, v120 offset:80
    ds_write_b32 v24, v126 offset:160
    ds_write_b32 v24, v124 offset:240
    ds_write_b32 v24, v123 offset:320
    ds_write_b32 v24, v125 offset:400
    ds_write_b32 v26, v125
    v_cndmask_b32 v126, 0, v126, vcc
    v_cndmask_b32 v127, 0, v127, vcc
    ds_read_b128 v[136:139], v25 offset:0
    ds_read_b128 v[140:143], v25 offset:16
    ds_read_b128 v[144:147], v25 offset:32
    ds_read_b128 v[148:151], v25 offset:48
    ds_read_b128 v[152:155], v25 offset:64
    ds_read_b128 v[156:159], v25 offset:80
    ds_read_b128 v[160:163], v25 offset:96
    ds_read_b128 v[164:167], v25 offset:112
    v_add_f32_dpp v126, v126, v126 row_shr:1 row_mask:0xf bank_mask:0xf
    v_add_f32_dpp v127, v127, v127 row_shr:1 row_mask:0xf bank_mask:0xf
    s_nop 0
    v_add_f32_dpp v126, v126, v126 row_shr:2 row_mask:0xf bank_mask:0xf
    v_add_f32_dpp v127, v127, v127 row_shr:2 row_mask:0xf bank_mask:0xf
    s_nop 0
    v_add_f32_dpp v126, v126, v126 row_shr:4 row_mask:0xf bank_mask:0xf
    v_add_f32_dpp v127, v127, v127 row_shr:4 row_mask:0xf bank_mask:0xf
    s_nop 0
    v_add_f32_dpp v126, v126, v126 row_shr:8 row_mask:0xf bank_mask:0xf
    v_add_f32_dpp v127, v127, v127 row_shr:8 row_mask:0xf bank_mask:0xf
    s_nop 0
    v_add_f32_dpp v126, v126, v126 row_bcast:15 row_mask:0xa bank_mask:0xf
    v_add_f32_dpp v127, v127, v127 row_bcast:15 row_mask:0xa bank_mask:0xf
    s_nop 0
    s_waitcnt lgkmcnt(4)
    ds_read_b128 v[168:171], v25 offset:128
    ds_read_b128 v[172:175], v25 offset:144
    ds_read_b128 v[176:179], v25 offset:160
    ds_read_b128 v[180:183], v25 offset:176
    ds_read_b128 v[184:187], v25 offset:192
    ds_read_b128 v[188:191], v25 offset:208
    ds_read_b128 v[192:195], v25 offset:224
    v_readlane_b32 s74, v126, 31
    v_readlane_b32 s75, v127, 31
    v_and_b32 v3, 1, v1
    v_cmp_eq_u32 vcc, 1, v3
    v_mov_b32 v4, s74
    v_mov_b32 v5, s75
    v_cndmask_b32 v64, v4, v5, vcc
    s_mov_b32 s14, 0
L_55:
    s_waitcnt vmcnt(0)
    v_cmp_eq_u32 vcc, s10, v62
    v_cmp_eq_u32 s[72:73], s11, v63
    s_and_b64 vcc, vcc, s[72:73]
    v_cmp_eq_u32 s[72:73], s10, v30
    s_and_b64 vcc, vcc, s[72:73]
    v_cmp_eq_u32 s[72:73], s11, v31
    s_and_b64 vcc, vcc, s[72:73]
    v_cmp_eq_u32 s[72:73], s10, v34
    s_and_b64 vcc, vcc, s[72:73]
    v_cmp_eq_u32 s[72:73], s11, v35
    s_and_b64 vcc, vcc, s[72:73]
    v_cmp_eq_u32 s[72:73], s10, v38
    s_and_b64 vcc, vcc, s[72:73]
    v_cmp_eq_u32 s[72:73], s11, v39
    s_and_b64 vcc, vcc, s[72:73]
    v_cmp_eq_u32 s[72:73], s10, v42
    s_and_b64 vcc, vcc, s[72:73]
    v_cmp_eq_u32 s[72:73], s11, v43
    s_and_b64 vcc, vcc, s[72:73]
    v_cmp_eq_u32 s[72:73], s10, v46
    s_and_b64 vcc, vcc, s[72:73]
    v_cmp_eq_u32 s[72:73], s11, v47
    s_and_b64 vcc, vcc, s[72:73]
    v_cmp_eq_u32 s[72:73], s10, v50
    s_and_b64 vcc, vcc, s[72:73]
    v_cmp_eq_u32 s[72:73], s11, v51
    s_and_b64 vcc, vcc, s[72:73]
    v_cmp_eq_u32 s[72:73], s10, v54
    s_and_b64 vcc, vcc, s[72:73]
    v_cmp_eq_u32 s[72:73], s11, v55
    s_and_b64 vcc, vcc, s[72:73]
    v_cmp_eq_u32 s[72:73], s10, v58
    s_and_b64 vcc, vcc, s[72:73]
    v_cmp_eq_u32 s[72:73], s11, v59
    s_and_b64 vcc, vcc, s[72:73]
    s_cmp_eq_u64 vcc, -1
    s_cbranch_scc1 L_56
    s_sleep 2
    global_load_dwordx2 v[62:63], v7, s[70:71] offset:2304 sc1
    global_load_dwordx4 v[28:31], v2, s[68:69] sc1
    global_load_dwordx4 v[32:35], v2, s[68:69] offset:3072 sc1
    global_load_dwordx4 v[36:39], v20, s[68:69] sc1
    global_load_dwordx4 v[40:43], v20, s[68:69] offset:3072 sc1
    global_load_dwordx4 v[44:47], v21, s[68:69] sc1
    global_load_dwordx4 v[48:51], v21, s[68:69] offset:3072 sc1
    global_load_dwordx4 v[52:55], v22, s[68:69] sc1
    global_load_dwordx4 v[56:59], v22, s[68:69] offset:3072 sc1
    s_add_u32 s14, s14, 1
    s_cmp_lt_u32 s14, 65536
    s_cbranch_scc1 L_55
    s_waitcnt vmcnt(0)
L_56:
    v_add_f32 v28, v28, v32
    v_add_f32 v29, v29, v33
    v_add_f32 v36, v36, v40
    v_add_f32 v37, v37, v41
    v_add_f32 v44, v44, v48
    v_add_f32 v45, v45, v49
    v_add_f32 v52, v52, v56
    v_add_f32 v53, v53, v57
    v_add_f32 v28, v28, v36
    v_add_f32 v29, v29, v37
    v_add_f32 v44, v44, v52
    v_add_f32 v45, v45, v53
    v_add_f32 v28, v28, v44
    v_add_f32 v29, v29, v45
    v_mul_f32 v62, 0x3acccccd, v28
    v_mul_f32 v7, 0x3acccccd, v29
    v_fma_f32 v7, -v62, v62, v7
    v_max_f32 v7, 0, v7
    v_add_f32 v7, 0x3727c5ac, v7
    v_rsq_f32 v63, v7
    s_nop 0
    v_mul_f32 v62, v62, v63
    v_fma_f32 v96, v76, v63, -v62
    v_fma_f32 v97, v77, v63, -v62
    v_fma_f32 v98, v78, v63, -v62
    v_fma_f32 v99, v79, v63, -v62
    v_fma_f32 v100, v80, v63, -v62
    v_fma_f32 v101, v81, v63, -v62
    v_fma_f32 v102, v82, v63, -v62
    v_fma_f32 v103, v83, v63, -v62
    v_fma_f32 v104, v84, v63, -v62
    v_fma_f32 v105, v85, v63, -v62
    v_fma_f32 v106, v86, v63, -v62
    v_fma_f32 v107, v87, v63, -v62
    v_fma_f32 v108, v88, v63, -v62
    v_fma_f32 v109, v89, v63, -v62
    v_fma_f32 v110, v90, v63, -v62
    v_fma_f32 v111, v91, v63, -v62
    v_fma_f32 v112, v92, v63, -v62
    v_fma_f32 v113, v93, v63, -v62
    v_fma_f32 v114, v94, v63, -v62
    v_fma_f32 v115, v95, v63, -v62
    s_waitcnt lgkmcnt(0)
    v_fma_f32 v96, v96, v136, v156
    v_fma_f32 v97, v97, v137, v157
    v_fma_f32 v98, v98, v138, v158
    v_fma_f32 v99, v99, v139, v159
    v_fma_f32 v100, v100, v140, v160
    v_fma_f32 v101, v101, v141, v161
    v_fma_f32 v102, v102, v142, v162
    v_fma_f32 v103, v103, v143, v163
    v_fma_f32 v104, v104, v144, v164
    v_fma_f32 v105, v105, v145, v165
    v_fma_f32 v106, v106, v146, v166
    v_fma_f32 v107, v107, v147, v167
    v_fma_f32 v108, v108, v148, v168
    v_fma_f32 v109, v109, v149, v169
    v_fma_f32 v110, v110, v150, v170
    v_fma_f32 v111, v111, v151, v171
    v_fma_f32 v112, v112, v152, v172
    v_fma_f32 v113, v113, v153, v173
    v_fma_f32 v114, v114, v154, v174
    v_fma_f32 v115, v115, v155, v175
    v_mov_b32 v51, v64
    s_setprio 3
    s_barrier
    ds_read_b64_tr_b16 v[116:117], v65 offset:0
    ds_read_b64_tr_b16 v[118:119], v65 offset:512
    ds_read_b64_tr_b16 v[120:121], v65 offset:1024
    ds_read_b64_tr_b16 v[122:123], v65 offset:1536
    ds_read_b64_tr_b16 v[124:125], v65 offset:2048
    s_waitcnt lgkmcnt(4)
    v_lshlrev_b32 v28, 16, v116
    v_and_b32 v29, 0xffff0000, v116
    v_pk_fma_f32 v[28:29], v[28:29], v[96:97], v[76:77]
    v_pk_mul_f32 v[128:129], v[28:29], v[28:29]
    v_pk_mul_f32 v[130:131], v[28:29], v[176:177]
    v_lshlrev_b32 v30, 16, v117
    v_and_b32 v31, 0xffff0000, v117
    v_pk_fma_f32 v[30:31], v[30:31], v[98:99], v[78:79]
    v_pk_add_f32 v[126:127], v[28:29], v[30:31]
    v_pk_fma_f32 v[128:129], v[30:31], v[30:31], v[128:129]
    v_pk_fma_f32 v[130:131], v[30:31], v[178:179], v[130:131]
    s_waitcnt lgkmcnt(3)
    v_lshlrev_b32 v32, 16, v118
    v_and_b32 v33, 0xffff0000, v118
    v_pk_fma_f32 v[32:33], v[32:33], v[100:101], v[80:81]
    v_pk_add_f32 v[126:127], v[126:127], v[32:33]
    v_pk_fma_f32 v[128:129], v[32:33], v[32:33], v[128:129]
    v_pk_fma_f32 v[130:131], v[32:33], v[180:181], v[130:131]
    v_lshlrev_b32 v34, 16, v119
    v_and_b32 v35, 0xffff0000, v119
    v_pk_fma_f32 v[34:35], v[34:35], v[102:103], v[82:83]
    v_pk_add_f32 v[126:127], v[126:127], v[34:35]
    v_pk_fma_f32 v[128:129], v[34:35], v[34:35], v[128:129]
    v_pk_fma_f32 v[130:131], v[34:35], v[182:183], v[130:131]
    s_waitcnt lgkmcnt(2)
    v_lshlrev_b32 v36, 16, v120
    v_and_b32 v37, 0xffff0000, v120
    v_pk_fma_f32 v[36:37], v[36:37], v[104:105], v[84:85]
    v_pk_add_f32 v[126:127], v[126:127], v[36:37]
    v_pk_fma_f32 v[128:129], v[36:37], v[36:37], v[128:129]
    v_pk_fma_f32 v[130:131], v[36:37], v[184:185], v[130:131]
    v_lshlrev_b32 v38, 16, v121
    v_and_b32 v39, 0xffff0000, v121
    v_pk_fma_f32 v[38:39], v[38:39], v[106:107], v[86:87]
    v_pk_add_f32 v[126:127], v[126:127], v[38:39]
    v_pk_fma_f32 v[128:129], v[38:39], v[38:39], v[128:129]
    v_pk_fma_f32 v[130:131], v[38:39], v[186:187], v[130:131]
    s_waitcnt lgkmcnt(1)
    v_lshlrev_b32 v40, 16, v122
    v_and_b32 v41, 0xffff0000, v122
    v_pk_fma_f32 v[40:41], v[40:41], v[108:109], v[88:89]
    v_pk_add_f32 v[126:127], v[126:127], v[40:41]
    v_pk_fma_f32 v[128:129], v[40:41], v[40:41], v[128:129]
    v_pk_fma_f32 v[130:131], v[40:41], v[188:189], v[130:131]
    v_lshlrev_b32 v42, 16, v123
    v_and_b32 v43, 0xffff0000, v123
    v_pk_fma_f32 v[42:43], v[42:43], v[110:111], v[90:91]
    v_pk_add_f32 v[126:127], v[126:127], v[42:43]
    v_pk_fma_f32 v[128:129], v[42:43], v[42:43], v[128:129]
    v_pk_fma_f32 v[130:131], v[42:43], v[190:191], v[130:131]
    s_waitcnt lgkmcnt(0)
    v_lshlrev_b32 v44, 16, v124
    v_and_b32 v45, 0xffff0000, v124
    v_pk_fma_f32 v[44:45], v[44:45], v[112:113], v[92:93]
    v_pk_add_f32 v[126:127], v[126:127], v[44:45]
    v_pk_fma_f32 v[128:129], v[44:45], v[44:45], v[128:129]
    v_pk_fma_f32 v[130:131], v[44:45], v[192:193], v[130:131]
    v_lshlrev_b32 v46, 16, v125
    v_and_b32 v47, 0xffff0000, v125
    v_pk_fma_f32 v[46:47], v[46:47], v[114:115], v[94:95]
    v_pk_add_f32 v[126:127], v[126:127], v[46:47]
    v_pk_fma_f32 v[128:129], v[46:47], v[46:47], v[128:129]
    v_pk_fma_f32 v[130:131], v[46:47], v[194:195], v[130:131]
    v_add_f32 v48, v126, v127
    v_add_f32 v49, v128, v129
    v_add_f32 v50, v130, v131
    ds_write_b128 v60, v[48:51]
    s_waitcnt lgkmcnt(0)
    s_barrier
    s_cmp_eq_u32 s15, 0
    s_cbranch_scc0 L_57
    ds_read_b128 v[76:79], v60 offset:0
    ds_read_b128 v[80:83], v60 offset:1024
    ds_read_b128 v[84:87], v60 offset:2048
    ds_read_b128 v[88:91], v60 offset:3072
    s_waitcnt lgkmcnt(0)
    v_pk_add_f32 v[76:77], v[76:77], v[80:81]
    v_pk_add_f32 v[78:79], v[78:79], v[82:83]
    v_pk_add_f32 v[84:85], v[84:85], v[88:89]
    v_pk_add_f32 v[86:87], v[86:87], v[90:91]
    v_pk_add_f32 v[76:77], v[76:77], v[84:85]
    v_pk_add_f32 v[78:79], v[78:79], v[86:87]
    v_or_b32 v76, 1, v76
    global_store_dwordx4 v2, v[76:79], s[62:63] offset:1024 sc1
L_57:
    ds_read_b128 v[196:199], v25 offset:240
    ds_read_b128 v[200:203], v25 offset:256
    ds_read_b128 v[204:207], v25 offset:272
    ds_read_b128 v[208:211], v25 offset:288
    ds_read_b128 v[212:215], v25 offset:304
    ds_read_b128 v[216:219], v25 offset:320
    ds_read_b128 v[220:223], v25 offset:336
    ds_read_b128 v[224:227], v25 offset:352
    ds_read_b128 v[228:231], v25 offset:368
    ds_read_b128 v[232:235], v25 offset:384
    ds_read_b128 v[236:239], v25 offset:400
    ds_read_b128 v[240:243], v25 offset:416
    ds_read_b128 v[244:247], v25 offset:432
    ds_read_b128 v[248:251], v25 offset:448
    ds_read_b128 v[252:255], v25 offset:464
    v_lshlrev_b32 v6, 3, v1
    v_add_u32 v6, 144896, v6
    v_mov_b32 v7, 151920
    s_cmp_eq_u32 s15, 0
    s_cbranch_scc0 L_58
    s_lshl_b32 s74, s5, 6
    s_sub_u32 s74, 0xfff, s74
    v_sub_u32 v56, s74, v1
    s_mov_b32 s75, 0xfffff000
    s_lshl_b32 s74, s5, 3
    v_mov_b32 v57, s74
    s_mov_b32 s14, 0
POLL_59:
    global_load_dwordx4 v[80:83], v2, s[64:65] sc1
    global_load_dwordx4 v[84:87], v2, s[64:65] offset:3072 sc1
    global_load_dwordx4 v[88:91], v20, s[64:65] sc1
    global_load_dwordx4 v[92:95], v20, s[64:65] offset:3072 sc1
    global_load_dwordx4 v[96:99], v21, s[64:65] sc1
    global_load_dwordx4 v[100:103], v21, s[64:65] offset:3072 sc1
    global_load_dwordx4 v[104:107], v22, s[64:65] sc1
    global_load_dwordx4 v[108:111], v22, s[64:65] offset:3072 sc1
    s_waitcnt vmcnt(0)
    v_and_b32 v3, v80, v84
    v_bitop3_b32 v3, v3, v88, v92 bitop3:0x80
    v_bitop3_b32 v3, v3, v96, v100 bitop3:0x80
    v_bitop3_b32 v3, v3, v104, v108 bitop3:0x80
    v_and_b32 v3, 1, v3
    v_cmp_eq_u32 vcc, 1, v3
    s_cmp_eq_u64 vcc, -1
    s_cbranch_scc1 POLLD_60
    s_add_u32 s14, s14, 1
    s_cmp_lt_u32 s14, 65536
    s_cbranch_scc1 POLL_59
POLLD_60:
    v_pk_add_f32 v[80:81], v[80:81], v[84:85]
    v_pk_add_f32 v[82:83], v[82:83], v[86:87]
    v_pk_add_f32 v[88:89], v[88:89], v[92:93]
    v_pk_add_f32 v[90:91], v[90:91], v[94:95]
    v_pk_add_f32 v[96:97], v[96:97], v[100:101]
    v_pk_add_f32 v[98:99], v[98:99], v[102:103]
    v_pk_add_f32 v[104:105], v[104:105], v[108:109]
    v_pk_add_f32 v[106:107], v[106:107], v[110:111]
    v_pk_add_f32 v[80:81], v[80:81], v[88:89]
    v_pk_add_f32 v[82:83], v[82:83], v[90:91]
    v_pk_add_f32 v[96:97], v[96:97], v[104:105]
    v_pk_add_f32 v[98:99], v[98:99], v[106:107]
    v_pk_add_f32 v[80:81], v[80:81], v[96:97]
    v_pk_add_f32 v[82:83], v[82:83], v[98:99]
    v_mul_f32 v52, 0x3acccccd, v80
    v_mul_f32 v3, 0x3acccccd, v81
    v_fma_f32 v3, -v52, v52, v3
    v_max_f32 v3, 0, v3
    v_add_f32 v3, 0x3727c5ac, v3
    v_rsq_f32 v53, v3
    v_mov_b32_dpp v54, v83 quad_perm:[0,0,2,2] row_mask:0xf bank_mask:0xf
    v_mov_b32_dpp v55, v83 quad_perm:[1,1,3,3] row_mask:0xf bank_mask:0xf
    ds_write_b64 v6, v[52:53]
    v_fma_f32 v54, -v52, v54, v82
    v_fma_f32 v54, v54, v53, v55
    v_ashrrev_i32 v55, 31, v54
    v_or_b32 v55, 0x80000000, v55
    v_xor_b32 v54, v54, v55
    v_and_or_b32 v54, v54, s75, v56
    s_nop 0
    v_mov_b32 v3, v54
    s_nop 0
    v_max_u32_dpp v3, v54, v54 row_shr:1 row_mask:0xf bank_mask:0xf
    s_nop 1
    v_max_u32_dpp v3, v3, v3 row_shr:2 row_mask:0xf bank_mask:0xf
    s_nop 1
    v_max_u32_dpp v3, v3, v3 row_shr:4 row_mask:0xf bank_mask:0xf
    s_nop 1
    v_max_u32_dpp v3, v3, v3 row_shr:8 row_mask:0xf bank_mask:0xf
    s_nop 1
    v_max_u32_dpp v3, v3, v3 row_bcast:15 row_mask:0xa bank_mask:0xf
    s_nop 1
    v_max_u32_dpp v3, v3, v3 row_bcast:31 row_mask:0xc bank_mask:0xf
    s_nop 0
    v_readlane_b32 s78, v3, 63
    s_nop 1
    v_cmp_eq_u32 vcc, s78, v54
    s_ff1_i32_b64 s80, vcc
    s_nop 0
    v_cndmask_b32 v54, v54, 0, vcc
    v_mov_b32 v3, v54
    s_nop 0
    v_max_u32_dpp v3, v54, v54 row_shr:1 row_mask:0xf bank_mask:0xf
    s_nop 1
    v_max_u32_dpp v3, v3, v3 row_shr:2 row_mask:0xf bank_mask:0xf
    s_nop 1
    v_max_u32_dpp v3, v3, v3 row_shr:4 row_mask:0xf bank_mask:0xf
    s_nop 1
    v_max_u32_dpp v3, v3, v3 row_shr:8 row_mask:0xf bank_mask:0xf
    s_nop 1
    v_max_u32_dpp v3, v3, v3 row_bcast:15 row_mask:0xa bank_mask:0xf
    s_nop 1
    v_max_u32_dpp v3, v3, v3 row_bcast:31 row_mask:0xc bank_mask:0xf
    s_nop 0
    v_readlane_b32 s79, v3, 63
    s_nop 1
    v_cmp_eq_u32 vcc, s79, v54
    s_ff1_i32_b64 s81, vcc
    v_mov_b32 v52, s78
    v_mov_b32 v53, s79
    v_mov_b32 v54, s80
    v_mov_b32 v55, s81
    s_mov_b64 exec, 1
    s_cmp_eq_u32 s12, 1
    s_cbranch_scc0 SLOWST_61
    global_store_dwordx2 v57, v[52:53], s[70:71] offset:2048
STD_62:
    ds_write_b64 v7, v[54:55]
    s_mov_b64 exec, -1
L_58:
    s_mul_i32 s74, s15, 48
    s_waitcnt lgkmcnt(0)
    s_barrier
    ds_read_b64 v[52:53], v6
    ds_read_b64 v[54:55], v7
    s_waitcnt lgkmcnt(1)
    v_pk_add_f32 v[76:77], v[28:29], v[52:53] op_sel_hi:[1,0] neg_lo:[0,1] neg_hi:[0,1]
    v_pk_add_f32 v[78:79], v[30:31], v[52:53] op_sel_hi:[1,0] neg_lo:[0,1] neg_hi:[0,1]
    v_pk_add_f32 v[80:81], v[32:33], v[52:53] op_sel_hi:[1,0] neg_lo:[0,1] neg_hi:[0,1]
    v_pk_add_f32 v[82:83], v[34:35], v[52:53] op_sel_hi:[1,0] neg_lo:[0,1] neg_hi:[0,1]
    v_pk_add_f32 v[84:85], v[36:37], v[52:53] op_sel_hi:[1,0] neg_lo:[0,1] neg_hi:[0,1]
    v_pk_add_f32 v[86:87], v[38:39], v[52:53] op_sel_hi:[1,0] neg_lo:[0,1] neg_hi:[0,1]
    v_pk_add_f32 v[88:89], v[40:41], v[52:53] op_sel_hi:[1,0] neg_lo:[0,1] neg_hi:[0,1]
    v_pk_add_f32 v[90:91], v[42:43], v[52:53] op_sel_hi:[1,0] neg_lo:[0,1] neg_hi:[0,1]
    v_pk_add_f32 v[92:93], v[44:45], v[52:53] op_sel_hi:[1,0] neg_lo:[0,1] neg_hi:[0,1]
    v_pk_add_f32 v[94:95], v[46:47], v[52:53] op_sel_hi:[1,0] neg_lo:[0,1] neg_hi:[0,1]
    s_waitcnt lgkmcnt(0)
    v_cmp_eq_u32 vcc, v54, v1
    v_cmp_eq_u32 s[72:73], v55, v1
    v_pk_mul_f32 v[76:77], v[76:77], v[52:53] op_sel:[0,1] op_sel_hi:[1,1]
    v_pk_mul_f32 v[78:79], v[78:79], v[52:53] op_sel:[0,1] op_sel_hi:[1,1]
    v_pk_mul_f32 v[80:81], v[80:81], v[52:53] op_sel:[0,1] op_sel_hi:[1,1]
    v_pk_mul_f32 v[82:83], v[82:83], v[52:53] op_sel:[0,1] op_sel_hi:[1,1]
    v_pk_mul_f32 v[84:85], v[84:85], v[52:53] op_sel:[0,1] op_sel_hi:[1,1]
    v_pk_mul_f32 v[86:87], v[86:87], v[52:53] op_sel:[0,1] op_sel_hi:[1,1]
    v_pk_mul_f32 v[88:89], v[88:89], v[52:53] op_sel:[0,1] op_sel_hi:[1,1]
    v_pk_mul_f32 v[90:91], v[90:91], v[52:53] op_sel:[0,1] op_sel_hi:[1,1]
    v_pk_mul_f32 v[92:93], v[92:93], v[52:53] op_sel:[0,1] op_sel_hi:[1,1]
    v_pk_mul_f32 v[94:95], v[94:95], v[52:53] op_sel:[0,1] op_sel_hi:[1,1]
    v_cndmask_b32 v5, 0, 1, s[72:73]
    s_or_b64 s[72:73], s[72:73], vcc
    v_pk_fma_f32 v[76:77], v[76:77], v[196:197], v[216:217]
    v_pk_fma_f32 v[78:79], v[78:79], v[198:199], v[218:219]
    v_pk_fma_f32 v[80:81], v[80:81], v[200:201], v[220:221]
    v_pk_fma_f32 v[82:83], v[82:83], v[202:203], v[222:223]
    v_pk_fma_f32 v[84:85], v[84:85], v[204:205], v[224:225]
    v_pk_fma_f32 v[86:87], v[86:87], v[206:207], v[226:227]
    v_pk_fma_f32 v[88:89], v[88:89], v[208:209], v[228:229]
    v_pk_fma_f32 v[90:91], v[90:91], v[210:211], v[230:231]
    v_pk_fma_f32 v[92:93], v[92:93], v[212:213], v[232:233]
    v_pk_fma_f32 v[94:95], v[94:95], v[214:215], v[234:235]
    v_mul_u32_u24 v6, 192, v5
    v_add_u32 v6, s74, v6
    s_mov_b64 exec, s[72:73]
    s_cmp_eq_u32 s12, 1
    s_cbranch_scc0 SLOWST_63
    v_cvt_pk_bf16_f32 v96, v76, v77
    v_cvt_pk_bf16_f32 v97, v78, v79
    v_cvt_pk_bf16_f32 v98, v80, v81
    v_cvt_pk_bf16_f32 v99, v82, 1.0
    global_store_dwordx4 v6, v[96:99], s[66:67] offset:0
    v_cvt_pk_bf16_f32 v100, v83, v84
    v_cvt_pk_bf16_f32 v101, v85, v86
    v_cvt_pk_bf16_f32 v102, v87, v88
    v_cvt_pk_bf16_f32 v103, v89, 1.0
    global_store_dwordx4 v6, v[100:103], s[66:67] offset:16
    v_cvt_pk_bf16_f32 v104, v90, v91
    v_cvt_pk_bf16_f32 v105, v92, v93
    v_cvt_pk_bf16_f32 v106, v94, v95
    v_cvt_pk_bf16_f32 v107, 0, 1.0
    global_store_dwordx4 v6, v[104:107], s[66:67] offset:32
STD_64:
    s_mov_b64 exec, -1
    s_setprio 0
    v_pk_fma_f32 v[76:77], v[76:77], v[236:237], v[28:29]
    v_pk_fma_f32 v[78:79], v[78:79], v[238:239], v[30:31]
    v_pk_fma_f32 v[80:81], v[80:81], v[240:241], v[32:33]
    v_pk_fma_f32 v[82:83], v[82:83], v[242:243], v[34:35]
    v_pk_fma_f32 v[84:85], v[84:85], v[244:245], v[36:37]
    v_pk_fma_f32 v[86:87], v[86:87], v[246:247], v[38:39]
    v_pk_fma_f32 v[88:89], v[88:89], v[248:249], v[40:41]
    v_pk_fma_f32 v[90:91], v[90:91], v[250:251], v[42:43]
    v_pk_fma_f32 v[92:93], v[92:93], v[252:253], v[44:45]
    v_pk_fma_f32 v[94:95], v[94:95], v[254:255], v[46:47]
    s_mul_i32 s74, s15, 80
    s_add_u32 s74, s74, 151936
    v_mul_u32_u24 v5, 320, v5
    v_add_u32 v5, s74, v5
    v_add_u32 v3, 32768, v19
    v_cvt_pk_bf16_f32 v116, v76, v77
    v_cvt_pk_bf16_f32 v117, v78, v79
    v_cvt_pk_bf16_f32 v118, v80, v81
    v_cvt_pk_bf16_f32 v119, v82, v83
    v_cvt_pk_bf16_f32 v120, v84, v85
    v_cvt_pk_bf16_f32 v121, v86, v87
    v_cvt_pk_bf16_f32 v122, v88, v89
    v_cvt_pk_bf16_f32 v123, v90, v91
    v_cvt_pk_bf16_f32 v124, v92, v93
    v_cvt_pk_bf16_f32 v125, v94, v95
    ds_write_b64 v3, v[116:117] offset:0
    ds_write_b64 v3, v[118:119] offset:8
    ds_write_b64 v3, v[120:121] offset:16
    ds_write_b64 v3, v[122:123] offset:24
    ds_write_b64 v3, v[124:125] offset:32
    s_mov_b64 exec, s[72:73]
    ds_write_b128 v5, v[76:79] offset:0
    ds_write_b128 v5, v[80:83] offset:16
    ds_write_b128 v5, v[84:87] offset:32
    ds_write_b128 v5, v[88:91] offset:48
    ds_write_b128 v5, v[92:95] offset:64
    s_mov_b64 exec, -1
    s_add_u32 s74, s7, 32768
    v_add_u32 v3, s74, v2
    s_waitcnt lgkmcnt(0)
    s_barrier
    ds_read_b128 v[12:15], v3
    ds_read_b128 v[16:19], v3 offset:4096
    ds_read_b128 v[20:23], v3 offset:8192
    s_waitcnt lgkmcnt(2)
    global_store_dwordx4 v8, v[12:15], s[42:43]
    s_waitcnt lgkmcnt(1)
    global_store_dwordx4 v9, v[16:19], s[42:43]
    s_cmp_lt_u32 s15, 2
    s_cbranch_scc0 L_65
    s_waitcnt lgkmcnt(0)
    global_store_dwordx4 v10, v[20:23], s[42:43]
L_65:
    s_waitcnt vmcnt(0) lgkmcnt(0)
    s_barrier
    s_branch L_FIX
L_END:
    s_endpgm
L_5:
    s_min_u32 s76, s5, 26
    s_mul_i32 s74, s76, 81920
    s_mul_i32 s75, s4, 276480
    v_mov_b32 v146, s52
    v_mov_b32 v147, s74
    v_mov_b32 v148, s75
    v_mov_b32 v149, 0
    v_mov_b32 v150, 1310720
    s_mov_b64 exec, 1
    global_load_dword v151, v146, s[42:43]
    global_load_dword v152, v147, s[36:37]
    global_load_dword v153, v148, s[32:33]
    global_load_dword v154, v148, s[34:35]
    global_load_dword v155, v149, s[18:19] sc1
    global_load_dword v156, v149, s[22:23] sc1
    global_load_dword v157, v150, s[46:47] sc1
    global_load_dword v158, v146, s[16:17]
    s_mov_b64 exec, -1
    s_waitcnt vmcnt(8)
    s_branch L_4
L_2:
    global_load_dwordx4 v[60:63], v2, s[70:71] sc1
    global_load_dwordx4 v[148:151], v2, s[70:71] offset:1024 sc1
    global_load_dword v152, v2, s[70:71] offset:2048 sc1
    s_waitcnt vmcnt(3)
    s_branch L_4
L_3:
    s_add_u32 s74, s11, s13
    s_lshl_b32 s75, s5, 6
    v_mov_b32 v148, s10
    v_mov_b32 v149, s74
    v_mov_b32 v146, s75
    s_mov_b64 exec, 1
    global_store_dwordx2 v146, v[148:149], s[62:63] sc1
    s_mov_b64 exec, -1
    s_waitcnt vmcnt(1)
    s_branch L_4
SLOWST_10:
    buffer_wbl2 sc1
    s_waitcnt vmcnt(0)
    global_store_dwordx2 v59, v[32:33], s[70:71] sc1
    s_branch STD_11
SLOWA_14:
    buffer_inv sc1
    s_waitcnt vmcnt(0)
    s_branch ACD_15
L_NOCONV:
    s_barrier
    s_branch L_CONVD
SLOWST_16:
    buffer_wbl2 sc1
    s_waitcnt vmcnt(0)
    global_store_dwordx2 v59, v[32:33], s[70:71] offset:1024 sc1
    s_branch STD_17
SLOWA_20:
    buffer_inv sc1
    s_waitcnt vmcnt(0)
    s_branch ACD_21
SLOWST_29:
    v_or_b32 v84, 1, v84
    v_or_b32 v85, 1, v85
    global_store_dword v7, v84, s[66:67] offset:384 sc1
    global_store_dword v7, v85, s[66:67] offset:704 sc1
    v_or_b32 v88, 1, v88
    v_or_b32 v89, 1, v89
    global_store_dword v7, v88, s[66:67] offset:448 sc1
    global_store_dword v7, v89, s[66:67] offset:768 sc1
    v_or_b32 v92, 1, v92
    v_or_b32 v93, 1, v93
    global_store_dword v7, v92, s[66:67] offset:512 sc1
    global_store_dword v7, v93, s[66:67] offset:832 sc1
    v_or_b32 v96, 1, v96
    v_or_b32 v97, 1, v97
    global_store_dword v7, v96, s[66:67] offset:576 sc1
    global_store_dword v7, v97, s[66:67] offset:896 sc1
    v_or_b32 v100, 1, v100
    v_or_b32 v101, 1, v101
    global_store_dword v7, v100, s[66:67] offset:640 sc1
    global_store_dword v7, v101, s[66:67] offset:960 sc1
    s_branch STD_30
SLOWST_51:
    global_store_dwordx2 v143, v[58:59], s[70:71] offset:2304 sc1
    s_branch STD_52
SLOWST_61:
    global_store_dwordx2 v57, v[52:53], s[70:71] offset:2048 sc1
    s_branch STD_62
SLOWST_63:
    v_cvt_pk_bf16_f32 v96, v76, v77
    v_cvt_pk_bf16_f32 v97, v78, v79
    v_cvt_pk_bf16_f32 v98, v80, v81
    v_cvt_pk_bf16_f32 v99, v82, 1.0
    global_store_dwordx4 v6, v[96:99], s[66:67] offset:0 sc1
    v_cvt_pk_bf16_f32 v100, v83, v84
    v_cvt_pk_bf16_f32 v101, v85, v86
    v_cvt_pk_bf16_f32 v102, v87, v88
    v_cvt_pk_bf16_f32 v103, v89, 1.0
    global_store_dwordx4 v6, v[100:103], s[66:67] offset:16 sc1
    v_cvt_pk_bf16_f32 v104, v90, v91
    v_cvt_pk_bf16_f32 v105, v92, v93
    v_cvt_pk_bf16_f32 v106, v94, v95
    v_cvt_pk_bf16_f32 v107, 0, 1.0
    global_store_dwordx4 v6, v[104:107], s[66:67] offset:32 sc1
    s_branch STD_64
.section .rodata,"a"
.p2align 6
.amdhsa_kernel adaLN_cond__ssm_conv_h3__moe_arch_mod__prompt_kernel
  .amdhsa_next_free_vgpr 256
  .amdhsa_next_free_sgpr 102
  .amdhsa_accum_offset 256
  .amdhsa_group_segment_fixed_size 0
  .amdhsa_kernarg_size 128
  .amdhsa_user_sgpr_count 2
  .amdhsa_user_sgpr_kernarg_segment_ptr 1
  .amdhsa_system_sgpr_workgroup_id_x 1
  .amdhsa_float_denorm_mode_32 3
.end_amdhsa_kernel
```
